```python
import torch

def _softmax(x, axis=-1):
    return torch.softmax(x, dim=axis)
def _gelu(x):
    return torch.nn.functional.gelu(x, approximate="tanh")
def _silu(x):
    return torch.nn.functional.silu(x)
def _sigmoid(x):
    return torch.sigmoid(x)
def _layernorm(x, axis=-1, eps=1e-5):
    m = x.mean(dim=axis, keepdim=True)
    v = x.var(dim=axis, keepdim=True, unbiased=False)
    return (x - m) / torch.sqrt(v + eps)
def _scatter_add(tgt, idx, src, axis=0):
    return tgt.clone().index_add_(axis, idx, src)
def _segment_sum(src, seg, n):
    out = torch.zeros((n,) + src.shape[1:], dtype=src.dtype)
    return out.index_add_(0, seg, src)
def _pad(x, pw):
    flat = tuple(v for pair in reversed(pw) for v in pair)
    return torch.nn.functional.pad(x, flat)

kernel_name = 'sequential_preLN__compressed_kv_cla__dense_activation_gelu__decode'

def setup_inputs():

    _w = (lambda a: (lambda t: t.to(torch.bfloat16) if t.is_floating_point() else t)(torch.as_tensor(a)))
    def _A_setup():
        B, H, Sq, Sk, D, M = 1, 32, 1, 16384, 128, 512
        Dc = 4 * D
        return {
            "x": _w((lambda *s: torch.randn(*s, dtype=torch.bfloat16) * 0.05)(B, Sq, M)),
            "c_kv": _w((lambda *s: torch.randn(*s, dtype=torch.bfloat16) * 0.8)(B, Sk, Dc)),
            "w_q": _w((lambda *s: torch.randn(*s, dtype=torch.bfloat16) * 3.2)(M, H, D) * (M ** -0.5)),
            "w_uk": _w((lambda *s: torch.randn(*s, dtype=torch.bfloat16) * 3.2)(Dc, H, D) * (Dc ** -0.5)),
            "w_uv": _w((lambda *s: torch.randn(*s, dtype=torch.bfloat16) * 0.8)(Dc, H, D) * (Dc ** -0.5)),
            "w_o": _w((lambda *s: torch.randn(*s, dtype=torch.bfloat16) * 0.8)(H, D, M) * ((H * D) ** -0.5)),
        }
    _A_in = _A_setup()

    def _B_setup():
        B, S, D, F = 1, 1, 512, 1792
        return {
            "x": _w((lambda *s: torch.randn(*s, dtype=torch.bfloat16) * 0.05)(B, S, D)),
            "w1": _w((lambda *s: torch.randn(*s, dtype=torch.bfloat16) * 3.2)(D, F) * (D ** -0.5)),
            "b1": _w((lambda *s: torch.randn(*s, dtype=torch.bfloat16) * 3.2)(F) * 0.01),
            "w2": _w((lambda *s: torch.randn(*s, dtype=torch.bfloat16) * 0.8)(F, D) * (F ** -0.5)),
            "b2": _w((lambda *s: torch.randn(*s, dtype=torch.bfloat16) * 0.8)(D) * 0.01),
        }
    _B_in = _B_setup()

    return {
        "A_x": _A_in["x"],
        "A_c_kv": _A_in["c_kv"],
        "A_w_q": _A_in["w_q"],
        "A_w_uk": _A_in["w_uk"],
        "A_w_uv": _A_in["w_uv"],
        "A_w_o": _A_in["w_o"],
        "B_x": _B_in["x"],
        "B_w1": _B_in["w1"],
        "B_b1": _B_in["b1"],
        "B_w2": _B_in["w2"],
        "B_b2": _B_in["b2"],
    }

def reference(A_x, A_c_kv, A_w_q, A_w_uk, A_w_uv, A_w_o, B_x, B_w1, B_b1, B_w2, B_b2):
    def _A_ref(x, c_kv, w_q, w_uk, w_uv, w_o):
        B, Sq, M = x.shape[0], x.shape[1], x.shape[2]
        Sk = c_kv.shape[1]
        H, D = w_q.shape[1], w_q.shape[2]
        q = torch.einsum("bqm,mhd->bhqd", x, w_q)
        k = torch.einsum("bkc,chd->bhkd", c_kv, w_uk)
        v = torch.einsum("bkc,chd->bhkd", c_kv, w_uv)
        scores = torch.einsum("bhqd,bhkd->bhqk", q, k) * (D ** -0.5)
        off = Sk - Sq
        qi = torch.arange(Sq)[:, None]
        kj = torch.arange(Sk)[None, :]
        cmask = kj <= (qi + off)
        scores = torch.where(cmask[None, None], scores, -1e9)
        p = _softmax(scores, axis=-1)
        ctx = torch.einsum("bhqk,bhkd->bhqd", p, v)
        return torch.einsum("bhqd,hdm->bqm", ctx, w_o)

    def _B_ref(x, w1, b1, w2, b2):
        h = torch.einsum("bsd,df->bsf", x, w1) + b1
        h = _gelu(h)
        return torch.einsum("bsf,fd->bsd", h, w2) + b2

    x = A_x
    h = x + _A_ref(_layernorm(x, axis=-1), A_c_kv, A_w_q, A_w_uk, A_w_uv, A_w_o)
    h2 = h + _B_ref(_layernorm(h, axis=-1), B_w1, B_b1, B_w2, B_b2)
    return h2
```

```asm
; @launch grid=(256,1,1) block=(512,1,1) lds=163840
.amdgcn_target "amdgcn-amd-amdhsa--gfx950"
.text
.globl sequential_preLN__compressed_kv_cla__dense_activation_gelu__decode_kernel
.p2align 8
.type sequential_preLN__compressed_kv_cla__dense_activation_gelu__decode_kernel,@function
sequential_preLN__compressed_kv_cla__dense_activation_gelu__decode_kernel:
    s_cmp_ge_u32 s2, 256
    s_cbranch_scc1 L_exit

    s_load_dwordx16 s[64:79], s[0:1], 0
    s_load_dwordx8 s[80:87], s[0:1], 64
    s_load_dwordx2 s[48:49], s[0:1], 104
    s_cmp_ge_u32 s2, 256
    s_cbranch_scc1 L_notcw
    s_getpc_b64 s[88:89]
L_tcw:
    v_lshlrev_b32 v18, 6, v0
    v_min_u32 v18, L_exit-L_tcw, v18
    global_load_dword v19, v18, s[88:89]
L_notcw:
    v_lshrrev_b32 v4, 6, v0
    v_and_b32 v1, 63, v0
    v_and_b32 v2, 15, v0
    v_readfirstlane_b32 s3, v4
    v_bfe_u32 v3, v0, 4, 2
    v_mov_b32 v5, 0
    v_mov_b32 v17, 0
    v_lshlrev_b32 v6, 4, v1
    v_mov_b32 v9, 152320
    v_mov_b32 v8, -1
    ds_write_b32 v9, v8
    ds_write_b32 v9, v8 offset:4
    ds_write_b32 v9, v8 offset:8
    ds_write_b32 v9, v8 offset:12
    ds_write_b32 v9, v8 offset:16
    ds_write_b32 v9, v8 offset:20
    v_lshlrev_b32 v31, 2, v1
    v_add_u32 v31, 151808, v31
    ds_write_b32 v31, v8
    s_mov_b32 s6, 1024
    s_mov_b32 s7, 0x20000
    s_mov_b32 s10, 16777216
    s_mov_b32 s11, 0x20000
    s_mov_b32 s14, 4194304
    s_mov_b32 s15, 0x20000
    s_mov_b32 s18, 4194304
    s_mov_b32 s19, 0x20000
    s_mov_b32 s22, 4194304
    s_mov_b32 s23, 0x20000
    s_mov_b32 s26, 4194304
    s_mov_b32 s27, 0x20000
    s_mov_b32 s30, 1835008
    s_mov_b32 s31, 0x20000
    s_mov_b32 s34, 3584
    s_mov_b32 s35, 0x20000
    s_mov_b32 s38, 1835008
    s_mov_b32 s39, 0x20000
    s_mov_b32 s42, 1024
    s_mov_b32 s43, 0x20000
    s_mov_b32 s46, 1024
    s_mov_b32 s47, 0x20000
    s_mov_b32 s50, 268435456
    s_mov_b32 s51, 0x20000
    s_and_b32 s52, s2, 7
    s_lshr_b32 s53, s2, 3
    s_lshr_b32 s54, s53, 3
    s_lshl_b32 s92, s52, 2
    s_add_u32 s54, s54, s92
    s_and_b32 s55, s53, 7
    s_lshr_b32 s58, s53, 1
    s_lshl_b32 s56, s52, 4
    s_add_u32 s56, s56, s58
    s_and_b32 s57, s53, 1
    s_bfe_u32 s63, s53, 0x20002
    s_lshl_b32 s63, s63, 5
    s_add_u32 s63, s63, s92
    s_and_b32 s93, s53, 3
    s_add_u32 s63, s63, s93
    s_mov_b32 s92, 0x00010001
    s_mov_b32 s93, 0x00010001
    s_mov_b32 s94, 0
    s_getreg_b32 s95, hwreg(HW_REG_XCC_ID)
    s_waitcnt lgkmcnt(0)
    s_mov_b64 s[4:5], s[64:65]
    s_mov_b64 s[12:13], s[68:69]
    s_mov_b64 s[16:17], s[70:71]
    s_mov_b64 s[8:9], s[66:67]
    s_mov_b64 s[20:21], s[72:73]
    s_mov_b64 s[24:25], s[74:75]
    s_mov_b64 s[28:29], s[78:79]
    s_mov_b64 s[32:33], s[80:81]
    s_mov_b64 s[36:37], s[82:83]
    s_mov_b64 s[40:41], s[84:85]
    s_mov_b64 s[44:45], s[86:87]
    s_load_dword s59, s[48:49], 0
    s_lshr_b32 s90, s58, 2
    s_lshl_b32 s64, s52, 2
    s_add_u32 s90, s90, s64
    s_and_b32 s91, s58, 3
    s_lshl_b32 s91, s91, 1
    s_bfe_u32 s64, s3, 0x10001
    s_xor_b32 s64, s64, 1
    s_add_u32 s91, s91, s64
    s_cmp_lt_u32 s3, 4
    s_cbranch_scc1 L_kw
    s_and_b32 s64, s3, 1
    s_cmp_lg_u32 s64, s57
    s_cbranch_scc1 L_vidle
    s_cmp_eq_u32 s57, 0
    s_cbranch_scc1 L_qawave
    s_setprio 3
    buffer_load_dwordx4 v[32:35], v6, s[4:7], 0 offen
    v_lshlrev_b32 v7, 5, v3
    s_lshl_b32 s64, s91, 7
    buffer_load_dwordx4 v[36:39], v7, s[4:7], s64 offen
    buffer_load_dwordx4 v[40:43], v7, s[4:7], s64 offen offset:16
    v_lshlrev_b32 v8, 17, v3
    v_lshl_add_u32 v8, v2, 4, v8
    s_lshl_b32 s65, s91, 19
    s_lshl_b32 s66, s90, 8
    s_add_u32 s65, s65, s66
    s_add_u32 s66, s65, 0
    buffer_load_dwordx4 v[64:67], v8, s[12:15], s66 offen nt
    s_add_u32 s66, s65, 8192
    buffer_load_dwordx4 v[68:71], v8, s[12:15], s66 offen nt
    s_add_u32 s66, s65, 16384
    buffer_load_dwordx4 v[72:75], v8, s[12:15], s66 offen nt
    s_add_u32 s66, s65, 24576
    buffer_load_dwordx4 v[76:79], v8, s[12:15], s66 offen nt
    s_add_u32 s66, s65, 32768
    buffer_load_dwordx4 v[80:83], v8, s[12:15], s66 offen nt
    s_add_u32 s66, s65, 40960
    buffer_load_dwordx4 v[84:87], v8, s[12:15], s66 offen nt
    s_add_u32 s66, s65, 49152
    buffer_load_dwordx4 v[88:91], v8, s[12:15], s66 offen nt
    s_add_u32 s66, s65, 57344
    buffer_load_dwordx4 v[92:95], v8, s[12:15], s66 offen nt
    s_add_u32 s66, s65, 65536
    buffer_load_dwordx4 v[96:99], v8, s[12:15], s66 offen nt
    s_add_u32 s66, s65, 73728
    buffer_load_dwordx4 v[100:103], v8, s[12:15], s66 offen nt
    s_add_u32 s66, s65, 81920
    buffer_load_dwordx4 v[104:107], v8, s[12:15], s66 offen nt
    s_add_u32 s66, s65, 90112
    buffer_load_dwordx4 v[108:111], v8, s[12:15], s66 offen nt
    s_add_u32 s66, s65, 98304
    buffer_load_dwordx4 v[112:115], v8, s[12:15], s66 offen nt
    s_add_u32 s66, s65, 106496
    buffer_load_dwordx4 v[116:119], v8, s[12:15], s66 offen nt
    s_add_u32 s66, s65, 114688
    buffer_load_dwordx4 v[120:123], v8, s[12:15], s66 offen nt
    s_add_u32 s66, s65, 122880
    buffer_load_dwordx4 v[124:127], v8, s[12:15], s66 offen nt
    s_barrier
    v_and_b32 v14, 1, v2
    v_lshlrev_b32 v14, 4, v14
    v_mov_b32 v15, 0xffff
    v_lshlrev_b32 v14, v14, v15
    v_lshrrev_b32 v15, 1, v2
    v_mov_b32 v16, 0
    v_cmp_eq_u32 vcc, 0, v15
    s_nop 1
    v_cndmask_b32 v10, v16, v14, vcc
    v_cmp_eq_u32 vcc, 1, v15
    s_nop 1
    v_cndmask_b32 v11, v16, v14, vcc
    v_cmp_eq_u32 vcc, 2, v15
    s_nop 1
    v_cndmask_b32 v12, v16, v14, vcc
    v_cmp_eq_u32 vcc, 3, v15
    s_nop 1
    v_cndmask_b32 v13, v16, v14, vcc
    s_waitcnt lgkmcnt(0)
    s_add_u32 s60, s59, 1
    s_xor_b32 s61, s59, 0x9e3779b9
    s_waitcnt vmcnt(18)
    v_lshlrev_b32 v16, 16, v32
    v_and_b32 v17, 0xffff0000, v32
    v_lshlrev_b32 v18, 16, v33
    v_and_b32 v19, 0xffff0000, v33
    v_lshlrev_b32 v20, 16, v34
    v_and_b32 v21, 0xffff0000, v34
    v_lshlrev_b32 v22, 16, v35
    v_and_b32 v23, 0xffff0000, v35
    v_add_f32 v24, v16, v17
    v_add_f32 v25, v18, v19
    v_add_f32 v26, v20, v21
    v_add_f32 v27, v22, v23
    v_add_f32 v24, v24, v25
    v_add_f32 v26, v26, v27
    v_add_f32 v24, v24, v26
    s_nop 1
    v_add_f32_dpp v24, v24, v24 quad_perm:[1,0,3,2] row_mask:0xf bank_mask:0xf
    s_nop 1
    v_add_f32_dpp v24, v24, v24 quad_perm:[2,3,0,1] row_mask:0xf bank_mask:0xf
    s_nop 1
    v_add_f32_dpp v24, v24, v24 row_half_mirror row_mask:0xf bank_mask:0xf
    s_nop 1
    v_add_f32_dpp v24, v24, v24 row_mirror row_mask:0xf bank_mask:0xf
    v_mov_b32 v25, v24
    s_nop 1
    v_permlane16_swap_b32 v24, v25
    v_add_f32 v24, v24, v25
    v_mov_b32 v25, v24
    s_nop 1
    v_permlane32_swap_b32 v24, v25
    v_add_f32 v24, v24, v25
    v_mul_f32 v24, 0x3b000000, v24
    v_sub_f32 v16, v16, v24
    v_sub_f32 v17, v17, v24
    v_sub_f32 v18, v18, v24
    v_sub_f32 v19, v19, v24
    v_sub_f32 v20, v20, v24
    v_sub_f32 v21, v21, v24
    v_sub_f32 v22, v22, v24
    v_sub_f32 v23, v23, v24
    v_mul_f32 v25, v16, v16
    v_fmac_f32 v25, v17, v17
    v_fmac_f32 v25, v18, v18
    v_fmac_f32 v25, v19, v19
    v_fmac_f32 v25, v20, v20
    v_fmac_f32 v25, v21, v21
    v_fmac_f32 v25, v22, v22
    v_fmac_f32 v25, v23, v23
    s_nop 1
    v_add_f32_dpp v25, v25, v25 quad_perm:[1,0,3,2] row_mask:0xf bank_mask:0xf
    s_nop 1
    v_add_f32_dpp v25, v25, v25 quad_perm:[2,3,0,1] row_mask:0xf bank_mask:0xf
    s_nop 1
    v_add_f32_dpp v25, v25, v25 row_half_mirror row_mask:0xf bank_mask:0xf
    s_nop 1
    v_add_f32_dpp v25, v25, v25 row_mirror row_mask:0xf bank_mask:0xf
    v_mov_b32 v26, v25
    s_nop 1
    v_permlane16_swap_b32 v25, v26
    v_add_f32 v25, v25, v26
    v_mov_b32 v26, v25
    s_nop 1
    v_permlane32_swap_b32 v25, v26
    v_add_f32 v25, v25, v26
    v_mov_b32 v26, 0x3727c5ac
    v_fmac_f32 v26, 0x3b000000, v25
    v_rsq_f32 v25, v26
    s_waitcnt vmcnt(16)
    v_mul_f32 v26, v24, v25
    v_lshlrev_b32 v16, 16, v36
    v_fma_f32 v16, v16, v25, -v26
    v_cvt_pk_bf16_f32 v17, v16, v16
    v_and_b32 v128, v17, v10
    v_and_b32 v129, v17, v11
    v_and_b32 v130, v17, v12
    v_and_b32 v131, v17, v13
    v_and_b32 v16, 0xffff0000, v36
    v_fma_f32 v16, v16, v25, -v26
    v_cvt_pk_bf16_f32 v17, v16, v16
    v_and_b32 v132, v17, v10
    v_and_b32 v133, v17, v11
    v_and_b32 v134, v17, v12
    v_and_b32 v135, v17, v13
    v_lshlrev_b32 v16, 16, v37
    v_fma_f32 v16, v16, v25, -v26
    v_cvt_pk_bf16_f32 v17, v16, v16
    v_and_b32 v136, v17, v10
    v_and_b32 v137, v17, v11
    v_and_b32 v138, v17, v12
    v_and_b32 v139, v17, v13
    v_and_b32 v16, 0xffff0000, v37
    v_fma_f32 v16, v16, v25, -v26
    v_cvt_pk_bf16_f32 v17, v16, v16
    v_and_b32 v140, v17, v10
    v_and_b32 v141, v17, v11
    v_and_b32 v142, v17, v12
    v_and_b32 v143, v17, v13
    v_lshlrev_b32 v16, 16, v38
    v_fma_f32 v16, v16, v25, -v26
    v_cvt_pk_bf16_f32 v17, v16, v16
    v_and_b32 v144, v17, v10
    v_and_b32 v145, v17, v11
    v_and_b32 v146, v17, v12
    v_and_b32 v147, v17, v13
    v_and_b32 v16, 0xffff0000, v38
    v_fma_f32 v16, v16, v25, -v26
    v_cvt_pk_bf16_f32 v17, v16, v16
    v_and_b32 v148, v17, v10
    v_and_b32 v149, v17, v11
    v_and_b32 v150, v17, v12
    v_and_b32 v151, v17, v13
    v_lshlrev_b32 v16, 16, v39
    v_fma_f32 v16, v16, v25, -v26
    v_cvt_pk_bf16_f32 v17, v16, v16
    v_and_b32 v152, v17, v10
    v_and_b32 v153, v17, v11
    v_and_b32 v154, v17, v12
    v_and_b32 v155, v17, v13
    v_and_b32 v16, 0xffff0000, v39
    v_fma_f32 v16, v16, v25, -v26
    v_cvt_pk_bf16_f32 v17, v16, v16
    v_and_b32 v156, v17, v10
    v_and_b32 v157, v17, v11
    v_and_b32 v158, v17, v12
    v_and_b32 v159, v17, v13
    v_lshlrev_b32 v16, 16, v40
    v_fma_f32 v16, v16, v25, -v26
    v_cvt_pk_bf16_f32 v17, v16, v16
    v_and_b32 v160, v17, v10
    v_and_b32 v161, v17, v11
    v_and_b32 v162, v17, v12
    v_and_b32 v163, v17, v13
    v_and_b32 v16, 0xffff0000, v40
    v_fma_f32 v16, v16, v25, -v26
    v_cvt_pk_bf16_f32 v17, v16, v16
    v_and_b32 v164, v17, v10
    v_and_b32 v165, v17, v11
    v_and_b32 v166, v17, v12
    v_and_b32 v167, v17, v13
    v_lshlrev_b32 v16, 16, v41
    v_fma_f32 v16, v16, v25, -v26
    v_cvt_pk_bf16_f32 v17, v16, v16
    v_and_b32 v168, v17, v10
    v_and_b32 v169, v17, v11
    v_and_b32 v170, v17, v12
    v_and_b32 v171, v17, v13
    v_and_b32 v16, 0xffff0000, v41
    v_fma_f32 v16, v16, v25, -v26
    v_cvt_pk_bf16_f32 v17, v16, v16
    v_and_b32 v172, v17, v10
    v_and_b32 v173, v17, v11
    v_and_b32 v174, v17, v12
    v_and_b32 v175, v17, v13
    v_lshlrev_b32 v16, 16, v42
    v_fma_f32 v16, v16, v25, -v26
    v_cvt_pk_bf16_f32 v17, v16, v16
    v_and_b32 v176, v17, v10
    v_and_b32 v177, v17, v11
    v_and_b32 v178, v17, v12
    v_and_b32 v179, v17, v13
    v_and_b32 v16, 0xffff0000, v42
    v_fma_f32 v16, v16, v25, -v26
    v_cvt_pk_bf16_f32 v17, v16, v16
    v_and_b32 v180, v17, v10
    v_and_b32 v181, v17, v11
    v_and_b32 v182, v17, v12
    v_and_b32 v183, v17, v13
    v_lshlrev_b32 v16, 16, v43
    v_fma_f32 v16, v16, v25, -v26
    v_cvt_pk_bf16_f32 v17, v16, v16
    v_and_b32 v184, v17, v10
    v_and_b32 v185, v17, v11
    v_and_b32 v186, v17, v12
    v_and_b32 v187, v17, v13
    v_and_b32 v16, 0xffff0000, v43
    v_fma_f32 v16, v16, v25, -v26
    v_cvt_pk_bf16_f32 v17, v16, v16
    v_and_b32 v188, v17, v10
    v_and_b32 v189, v17, v11
    v_and_b32 v190, v17, v12
    v_and_b32 v191, v17, v13
    s_lshl_b32 s64, s90, 13
    s_lshl_b32 s100, s91, 10
    s_add_u32 s100, s100, s64
    s_add_u32 s100, s100, 65536
    v_mov_b32 v50, s60
    v_mov_b32 v51, s61
    v_mov_b32 v54, s60
    v_mov_b32 v55, s61
    s_waitcnt vmcnt(15)
    v_mfma_f32_16x16x32_bf16 v[20:23], v[128:131], v[64:67], 0
    s_waitcnt vmcnt(14)
    v_mfma_f32_16x16x32_bf16 v[20:23], v[132:135], v[68:71], v[20:23]
    s_waitcnt vmcnt(13)
    v_mfma_f32_16x16x32_bf16 v[20:23], v[136:139], v[72:75], v[20:23]
    s_waitcnt vmcnt(12)
    v_mfma_f32_16x16x32_bf16 v[20:23], v[140:143], v[76:79], v[20:23]
    s_waitcnt vmcnt(11)
    v_mfma_f32_16x16x32_bf16 v[20:23], v[144:147], v[80:83], v[20:23]
    s_waitcnt vmcnt(10)
    v_mfma_f32_16x16x32_bf16 v[20:23], v[148:151], v[84:87], v[20:23]
    s_waitcnt vmcnt(9)
    v_mfma_f32_16x16x32_bf16 v[20:23], v[152:155], v[88:91], v[20:23]
    s_waitcnt vmcnt(8)
    v_mfma_f32_16x16x32_bf16 v[20:23], v[156:159], v[92:95], v[20:23]
    s_waitcnt vmcnt(7)
    v_mfma_f32_16x16x32_bf16 v[20:23], v[160:163], v[96:99], v[20:23]
    s_waitcnt vmcnt(6)
    v_mfma_f32_16x16x32_bf16 v[20:23], v[164:167], v[100:103], v[20:23]
    s_waitcnt vmcnt(5)
    v_mfma_f32_16x16x32_bf16 v[20:23], v[168:171], v[104:107], v[20:23]
    s_waitcnt vmcnt(4)
    v_mfma_f32_16x16x32_bf16 v[20:23], v[172:175], v[108:111], v[20:23]
    s_waitcnt vmcnt(3)
    v_mfma_f32_16x16x32_bf16 v[20:23], v[176:179], v[112:115], v[20:23]
    s_waitcnt vmcnt(2)
    v_mfma_f32_16x16x32_bf16 v[20:23], v[180:183], v[116:119], v[20:23]
    s_waitcnt vmcnt(1)
    v_mfma_f32_16x16x32_bf16 v[20:23], v[184:187], v[120:123], v[20:23]
    s_waitcnt vmcnt(0)
    v_mfma_f32_16x16x32_bf16 v[20:23], v[188:191], v[124:127], v[20:23]
    s_nop 7
    v_mov_b32 v48, v20
    v_mov_b32 v49, v21
    v_mov_b32 v52, v22
    v_mov_b32 v53, v23

    s_mov_b32 exec_hi, 0
    buffer_store_dwordx4 v[48:51], v6, s[48:51], s100 offen
    buffer_store_dwordx4 v[52:55], v6, s[48:51], s100 offen offset:512
    s_mov_b64 exec, -1
    s_setprio 0
    s_cmp_eq_u32 s3, 5
    s_cbranch_scc1 Lq5_1
    v_mov_b32 v9, 152320
    v_mov_b32 v8, 1
    ds_write_b32 v9, v8 offset:4
    s_branch Lq6_2
Lq5_1:
    v_mov_b32 v9, 152320
    v_mov_b32 v8, 1
    ds_write_b32 v9, v8 offset:20
Lq6_2:
    s_lshl_b32 s65, s52, 9
    s_add_u32 s65, s65, 4096
    v_and_b32 v7, 31, v1
    v_lshlrev_b32 v7, 4, v7
    buffer_load_dwordx4 v[56:59], v7, s[48:51], s65 offen sc1
    s_waitcnt vmcnt(0)
    v_cmp_ne_u64 s[76:77], v[58:59], s[60:61]
    v_cmp_ne_u32 vcc, s95, v56
    s_or_b64 s[74:75], vcc, s[76:77]
    s_cbranch_scc0 Lxe_3
    s_mov_b32 exec_hi, 0
    buffer_store_dwordx4 v[48:51], v6, s[48:51], s100 offen sc1
    buffer_store_dwordx4 v[52:55], v6, s[48:51], s100 offen offset:512 sc1
    s_mov_b64 exec, -1
Lxe_3:
    s_branch L_s2
L_vidle:
    s_barrier
    s_waitcnt lgkmcnt(0)
    s_add_u32 s60, s59, 1
    s_xor_b32 s61, s59, 0x9e3779b9
    s_branch L_s2
L_kw:
    v_xor_b32 v40, 0, v6
    v_xor_b32 v41, 32, v6
    v_xor_b32 v42, 64, v6
    v_xor_b32 v43, 96, v6
    v_xor_b32 v44, 128, v6
    v_xor_b32 v45, 160, v6
    v_xor_b32 v46, 192, v6
    v_xor_b32 v47, 224, v6
    s_lshl_b32 s64, s56, 17
    s_lshl_b32 s70, s3, 14
    s_add_u32 s71, s70, 0x10000
    s_barrier
    s_waitcnt lgkmcnt(0)
    s_add_u32 s60, s59, 1
    s_xor_b32 s61, s59, 0x9e3779b9
    s_cmp_lg_u32 s3, 0
    s_cbranch_scc1 Lk_4
    v_mov_b32 v32, s95
    v_mov_b32 v33, s95
    v_mov_b32 v34, s60
    v_mov_b32 v35, s61
    s_lshl_b32 s65, s52, 9
    s_lshl_b32 s66, s53, 4
    s_add_u32 s66, s66, s65
    s_add_u32 s66, s66, 4096
    v_mov_b32 v36, 0
    s_mov_b64 exec, 1
    buffer_store_dwordx4 v[32:35], v36, s[48:51], s66 offen sc1
    s_mov_b64 exec, -1
Lk_4:
    s_cmp_eq_u32 s57, 1
    s_cbranch_scc1 L_kgo
    v_mov_b32 v9, 152320
    s_mov_b32 s79, 0
Lw_5:

    ds_read_b32 v8, v9 offset:16
    s_waitcnt lgkmcnt(0)
    v_readfirstlane_b32 s78, v8
    s_add_u32 s79, s79, 1
    s_cmp_gt_u32 s79, 2000000
    s_cbranch_scc1 Lx_6
    s_cmp_eq_u32 s78, -1
    s_cbranch_scc1 Lw_5
Lx_6:
    s_add_u32 s66, s70, 0
    s_mov_b32 m0, s66
    s_add_u32 s67, s64, s66
    buffer_load_dwordx4 v40, s[8:11], s67 offen lds
    s_waitcnt vmcnt(11)
    s_add_u32 s66, s70, 1024
    s_mov_b32 m0, s66
    s_add_u32 s67, s64, s66
    buffer_load_dwordx4 v41, s[8:11], s67 offen lds
    s_waitcnt vmcnt(11)
    s_add_u32 s66, s70, 2048
    s_mov_b32 m0, s66
    s_add_u32 s67, s64, s66
    buffer_load_dwordx4 v42, s[8:11], s67 offen lds
    s_waitcnt vmcnt(11)
    s_add_u32 s66, s70, 3072
    s_mov_b32 m0, s66
    s_add_u32 s67, s64, s66
    buffer_load_dwordx4 v43, s[8:11], s67 offen lds
    s_waitcnt vmcnt(11)
    s_add_u32 s66, s70, 4096
    s_mov_b32 m0, s66
    s_add_u32 s67, s64, s66
    buffer_load_dwordx4 v44, s[8:11], s67 offen lds
    s_waitcnt vmcnt(11)
    s_add_u32 s66, s70, 5120
    s_mov_b32 m0, s66
    s_add_u32 s67, s64, s66
    buffer_load_dwordx4 v45, s[8:11], s67 offen lds
    s_waitcnt vmcnt(11)
    s_add_u32 s66, s70, 6144
    s_mov_b32 m0, s66
    s_add_u32 s67, s64, s66
    buffer_load_dwordx4 v46, s[8:11], s67 offen lds
    s_waitcnt vmcnt(11)
    s_add_u32 s66, s70, 7168
    s_mov_b32 m0, s66
    s_add_u32 s67, s64, s66
    buffer_load_dwordx4 v47, s[8:11], s67 offen lds
    s_waitcnt vmcnt(11)
    s_add_u32 s66, s70, 8192
    s_mov_b32 m0, s66
    s_add_u32 s67, s64, s66
    buffer_load_dwordx4 v40, s[8:11], s67 offen lds
    s_waitcnt vmcnt(11)
    s_add_u32 s66, s70, 9216
    s_mov_b32 m0, s66
    s_add_u32 s67, s64, s66
    buffer_load_dwordx4 v41, s[8:11], s67 offen lds
    s_waitcnt vmcnt(11)
    s_add_u32 s66, s70, 10240
    s_mov_b32 m0, s66
    s_add_u32 s67, s64, s66
    buffer_load_dwordx4 v42, s[8:11], s67 offen lds
    s_waitcnt vmcnt(11)
    s_add_u32 s66, s70, 11264
    s_mov_b32 m0, s66
    s_add_u32 s67, s64, s66
    buffer_load_dwordx4 v43, s[8:11], s67 offen lds
    s_waitcnt vmcnt(11)
    s_add_u32 s66, s70, 12288
    s_mov_b32 m0, s66
    s_add_u32 s67, s64, s66
    buffer_load_dwordx4 v44, s[8:11], s67 offen lds
    s_waitcnt vmcnt(11)
    s_add_u32 s66, s70, 13312
    s_mov_b32 m0, s66
    s_add_u32 s67, s64, s66
    buffer_load_dwordx4 v45, s[8:11], s67 offen lds
    s_waitcnt vmcnt(11)
    s_add_u32 s66, s70, 14336
    s_mov_b32 m0, s66
    s_add_u32 s67, s64, s66
    buffer_load_dwordx4 v46, s[8:11], s67 offen lds
    s_waitcnt vmcnt(11)
    s_add_u32 s66, s70, 15360
    s_mov_b32 m0, s66
    s_add_u32 s67, s64, s66
    buffer_load_dwordx4 v47, s[8:11], s67 offen lds
    s_waitcnt vmcnt(11)
    v_mov_b32 v9, 152320
    s_mov_b32 s79, 0
Lw_7:

    ds_read_b32 v8, v9 offset:20
    s_waitcnt lgkmcnt(0)
    v_readfirstlane_b32 s78, v8
    s_add_u32 s79, s79, 1
    s_cmp_gt_u32 s79, 2000000
    s_cbranch_scc1 Lx_8
    s_cmp_eq_u32 s78, -1
    s_cbranch_scc1 Lw_7
Lx_8:
    s_add_u32 s66, s71, 0
    s_mov_b32 m0, s66
    s_add_u32 s67, s64, s66
    buffer_load_dwordx4 v40, s[8:11], s67 offen lds
    s_waitcnt vmcnt(11)
    s_add_u32 s66, s71, 1024
    s_mov_b32 m0, s66
    s_add_u32 s67, s64, s66
    buffer_load_dwordx4 v41, s[8:11], s67 offen lds
    s_waitcnt vmcnt(11)
    s_add_u32 s66, s71, 2048
    s_mov_b32 m0, s66
    s_add_u32 s67, s64, s66
    buffer_load_dwordx4 v42, s[8:11], s67 offen lds
    s_waitcnt vmcnt(11)
    s_add_u32 s66, s71, 3072
    s_mov_b32 m0, s66
    s_add_u32 s67, s64, s66
    buffer_load_dwordx4 v43, s[8:11], s67 offen lds
    s_waitcnt vmcnt(11)
    s_add_u32 s66, s71, 4096
    s_mov_b32 m0, s66
    s_add_u32 s67, s64, s66
    buffer_load_dwordx4 v44, s[8:11], s67 offen lds
    s_waitcnt vmcnt(11)
    s_add_u32 s66, s71, 5120
    s_mov_b32 m0, s66
    s_add_u32 s67, s64, s66
    buffer_load_dwordx4 v45, s[8:11], s67 offen lds
    s_waitcnt vmcnt(11)
    s_add_u32 s66, s71, 6144
    s_mov_b32 m0, s66
    s_add_u32 s67, s64, s66
    buffer_load_dwordx4 v46, s[8:11], s67 offen lds
    s_waitcnt vmcnt(11)
    s_add_u32 s66, s71, 7168
    s_mov_b32 m0, s66
    s_add_u32 s67, s64, s66
    buffer_load_dwordx4 v47, s[8:11], s67 offen lds
    s_waitcnt vmcnt(11)
    s_add_u32 s66, s71, 8192
    s_mov_b32 m0, s66
    s_add_u32 s67, s64, s66
    buffer_load_dwordx4 v40, s[8:11], s67 offen lds
    s_waitcnt vmcnt(11)
    s_add_u32 s66, s71, 9216
    s_mov_b32 m0, s66
    s_add_u32 s67, s64, s66
    buffer_load_dwordx4 v41, s[8:11], s67 offen lds
    s_waitcnt vmcnt(11)
    s_add_u32 s66, s71, 10240
    s_mov_b32 m0, s66
    s_add_u32 s67, s64, s66
    buffer_load_dwordx4 v42, s[8:11], s67 offen lds
    s_waitcnt vmcnt(11)
    s_add_u32 s66, s71, 11264
    s_mov_b32 m0, s66
    s_add_u32 s67, s64, s66
    buffer_load_dwordx4 v43, s[8:11], s67 offen lds
    s_waitcnt vmcnt(11)
    s_add_u32 s66, s71, 12288
    s_mov_b32 m0, s66
    s_add_u32 s67, s64, s66
    buffer_load_dwordx4 v44, s[8:11], s67 offen lds
    s_waitcnt vmcnt(11)
    s_add_u32 s66, s71, 13312
    s_mov_b32 m0, s66
    s_add_u32 s67, s64, s66
    buffer_load_dwordx4 v45, s[8:11], s67 offen lds
    s_waitcnt vmcnt(11)
    s_add_u32 s66, s71, 14336
    s_mov_b32 m0, s66
    s_add_u32 s67, s64, s66
    buffer_load_dwordx4 v46, s[8:11], s67 offen lds
    s_waitcnt vmcnt(11)
    s_add_u32 s66, s71, 15360
    s_mov_b32 m0, s66
    s_add_u32 s67, s64, s66
    buffer_load_dwordx4 v47, s[8:11], s67 offen lds
    s_waitcnt vmcnt(11)
    s_branch L_kdone
L_kgo:
    s_add_u32 s66, s70, 0
    s_mov_b32 m0, s66
    s_add_u32 s67, s64, s66
    buffer_load_dwordx4 v40, s[8:11], s67 offen lds
    s_waitcnt vmcnt(15)
    s_add_u32 s66, s70, 1024
    s_mov_b32 m0, s66
    s_add_u32 s67, s64, s66
    buffer_load_dwordx4 v41, s[8:11], s67 offen lds
    s_waitcnt vmcnt(15)
    s_add_u32 s66, s70, 2048
    s_mov_b32 m0, s66
    s_add_u32 s67, s64, s66
    buffer_load_dwordx4 v42, s[8:11], s67 offen lds
    s_waitcnt vmcnt(15)
    s_add_u32 s66, s70, 3072
    s_mov_b32 m0, s66
    s_add_u32 s67, s64, s66
    buffer_load_dwordx4 v43, s[8:11], s67 offen lds
    s_waitcnt vmcnt(15)
    v_mov_b32 v9, 152320
    s_mov_b32 s79, 0
Lw_9:

    ds_read_b32 v8, v9 offset:4
    s_waitcnt lgkmcnt(0)
    v_readfirstlane_b32 s78, v8
    s_add_u32 s79, s79, 1
    s_cmp_gt_u32 s79, 2000000
    s_cbranch_scc1 Lx_10
    s_cmp_eq_u32 s78, -1
    s_cbranch_scc1 Lw_9
Lx_10:
    v_mov_b32 v9, 152320
    s_mov_b32 s79, 0
Lw_11:

    ds_read_b32 v8, v9 offset:20
    s_waitcnt lgkmcnt(0)
    v_readfirstlane_b32 s78, v8
    s_add_u32 s79, s79, 1
    s_cmp_gt_u32 s79, 2000000
    s_cbranch_scc1 Lx_12
    s_cmp_eq_u32 s78, -1
    s_cbranch_scc1 Lw_11
Lx_12:
    s_add_u32 s66, s70, 4096
    s_mov_b32 m0, s66
    s_add_u32 s67, s64, s66
    buffer_load_dwordx4 v44, s[8:11], s67 offen lds
    s_waitcnt vmcnt(15)
    s_add_u32 s66, s70, 5120
    s_mov_b32 m0, s66
    s_add_u32 s67, s64, s66
    buffer_load_dwordx4 v45, s[8:11], s67 offen lds
    s_waitcnt vmcnt(15)
    s_add_u32 s66, s70, 6144
    s_mov_b32 m0, s66
    s_add_u32 s67, s64, s66
    buffer_load_dwordx4 v46, s[8:11], s67 offen lds
    s_waitcnt vmcnt(15)
    s_add_u32 s66, s70, 7168
    s_mov_b32 m0, s66
    s_add_u32 s67, s64, s66
    buffer_load_dwordx4 v47, s[8:11], s67 offen lds
    s_waitcnt vmcnt(15)
    s_add_u32 s66, s70, 8192
    s_mov_b32 m0, s66
    s_add_u32 s67, s64, s66
    buffer_load_dwordx4 v40, s[8:11], s67 offen lds
    s_waitcnt vmcnt(15)
    s_add_u32 s66, s70, 9216
    s_mov_b32 m0, s66
    s_add_u32 s67, s64, s66
    buffer_load_dwordx4 v41, s[8:11], s67 offen lds
    s_waitcnt vmcnt(15)
    s_add_u32 s66, s70, 10240
    s_mov_b32 m0, s66
    s_add_u32 s67, s64, s66
    buffer_load_dwordx4 v42, s[8:11], s67 offen lds
    s_waitcnt vmcnt(15)
    s_add_u32 s66, s70, 11264
    s_mov_b32 m0, s66
    s_add_u32 s67, s64, s66
    buffer_load_dwordx4 v43, s[8:11], s67 offen lds
    s_waitcnt vmcnt(15)
    s_add_u32 s66, s70, 12288
    s_mov_b32 m0, s66
    s_add_u32 s67, s64, s66
    buffer_load_dwordx4 v44, s[8:11], s67 offen lds
    s_waitcnt vmcnt(15)
    s_add_u32 s66, s70, 13312
    s_mov_b32 m0, s66
    s_add_u32 s67, s64, s66
    buffer_load_dwordx4 v45, s[8:11], s67 offen lds
    s_waitcnt vmcnt(15)
    s_add_u32 s66, s70, 14336
    s_mov_b32 m0, s66
    s_add_u32 s67, s64, s66
    buffer_load_dwordx4 v46, s[8:11], s67 offen lds
    s_waitcnt vmcnt(15)
    s_add_u32 s66, s70, 15360
    s_mov_b32 m0, s66
    s_add_u32 s67, s64, s66
    buffer_load_dwordx4 v47, s[8:11], s67 offen lds
    s_waitcnt vmcnt(15)
    s_add_u32 s66, s71, 0
    s_mov_b32 m0, s66
    s_add_u32 s67, s64, s66
    buffer_load_dwordx4 v40, s[8:11], s67 offen lds
    s_waitcnt vmcnt(15)
    s_add_u32 s66, s71, 1024
    s_mov_b32 m0, s66
    s_add_u32 s67, s64, s66
    buffer_load_dwordx4 v41, s[8:11], s67 offen lds
    s_waitcnt vmcnt(15)
    s_add_u32 s66, s71, 2048
    s_mov_b32 m0, s66
    s_add_u32 s67, s64, s66
    buffer_load_dwordx4 v42, s[8:11], s67 offen lds
    s_waitcnt vmcnt(15)
    s_add_u32 s66, s71, 3072
    s_mov_b32 m0, s66
    s_add_u32 s67, s64, s66
    buffer_load_dwordx4 v43, s[8:11], s67 offen lds
    s_waitcnt vmcnt(15)
    v_mov_b32 v9, 152320
    v_mov_b32 v8, 1
    ds_write_b32 v9, v8 offset:8
    v_mov_b32 v9, 152320
    v_mov_b32 v8, 1
    ds_write_b32 v9, v8 offset:12
    s_add_u32 s66, s71, 4096
    s_mov_b32 m0, s66
    s_add_u32 s67, s64, s66
    buffer_load_dwordx4 v44, s[8:11], s67 offen lds
    s_waitcnt vmcnt(15)
    s_add_u32 s66, s71, 5120
    s_mov_b32 m0, s66
    s_add_u32 s67, s64, s66
    buffer_load_dwordx4 v45, s[8:11], s67 offen lds
    s_waitcnt vmcnt(15)
    s_add_u32 s66, s71, 6144
    s_mov_b32 m0, s66
    s_add_u32 s67, s64, s66
    buffer_load_dwordx4 v46, s[8:11], s67 offen lds
    s_waitcnt vmcnt(15)
    s_add_u32 s66, s71, 7168
    s_mov_b32 m0, s66
    s_add_u32 s67, s64, s66
    buffer_load_dwordx4 v47, s[8:11], s67 offen lds
    s_waitcnt vmcnt(15)
    s_add_u32 s66, s71, 8192
    s_mov_b32 m0, s66
    s_add_u32 s67, s64, s66
    buffer_load_dwordx4 v40, s[8:11], s67 offen lds
    s_waitcnt vmcnt(15)
    s_add_u32 s66, s71, 9216
    s_mov_b32 m0, s66
    s_add_u32 s67, s64, s66
    buffer_load_dwordx4 v41, s[8:11], s67 offen lds
    s_waitcnt vmcnt(15)
    s_add_u32 s66, s71, 10240
    s_mov_b32 m0, s66
    s_add_u32 s67, s64, s66
    buffer_load_dwordx4 v42, s[8:11], s67 offen lds
    s_waitcnt vmcnt(15)
    s_add_u32 s66, s71, 11264
    s_mov_b32 m0, s66
    s_add_u32 s67, s64, s66
    buffer_load_dwordx4 v43, s[8:11], s67 offen lds
    s_waitcnt vmcnt(15)
    s_add_u32 s66, s71, 12288
    s_mov_b32 m0, s66
    s_add_u32 s67, s64, s66
    buffer_load_dwordx4 v44, s[8:11], s67 offen lds
    s_waitcnt vmcnt(15)
    s_add_u32 s66, s71, 13312
    s_mov_b32 m0, s66
    s_add_u32 s67, s64, s66
    buffer_load_dwordx4 v45, s[8:11], s67 offen lds
    s_waitcnt vmcnt(15)
    s_add_u32 s66, s71, 14336
    s_mov_b32 m0, s66
    s_add_u32 s67, s64, s66
    buffer_load_dwordx4 v46, s[8:11], s67 offen lds
    s_waitcnt vmcnt(15)
    s_add_u32 s66, s71, 15360
    s_mov_b32 m0, s66
    s_add_u32 s67, s64, s66
    buffer_load_dwordx4 v47, s[8:11], s67 offen lds
    s_waitcnt vmcnt(15)
L_kdone:
    v_and_b32 v7, 7, v2
    v_lshlrev_b32 v7, 1, v7
    v_add_u32 v8, 0, v3
    v_xor_b32 v8, v8, v7
    v_lshlrev_b32 v8, 4, v8
    v_lshl_add_u32 v8, v2, 10, v8
    v_add_u32 v10, s70, v8
    v_add_u32 v14, 131072, v8
    v_add_u32 v18, s71, v8
    v_add_u32 v8, 4, v3
    v_xor_b32 v8, v8, v7
    v_lshlrev_b32 v8, 4, v8
    v_lshl_add_u32 v8, v2, 10, v8
    v_add_u32 v11, s70, v8
    v_add_u32 v15, 131072, v8
    v_add_u32 v19, s71, v8
    v_add_u32 v8, 8, v3
    v_xor_b32 v8, v8, v7
    v_lshlrev_b32 v8, 4, v8
    v_lshl_add_u32 v8, v2, 10, v8
    v_add_u32 v12, s70, v8
    v_add_u32 v16, 131072, v8
    v_add_u32 v20, s71, v8
    v_add_u32 v8, 12, v3
    v_xor_b32 v8, v8, v7
    v_lshlrev_b32 v8, 4, v8
    v_lshl_add_u32 v8, v2, 10, v8
    v_add_u32 v13, s70, v8
    v_add_u32 v17, 131072, v8
    v_add_u32 v21, s71, v8
    s_waitcnt vmcnt(0)
    ds_read_b128 v[64:67], v10 offset:0
    ds_read_b128 v[68:71], v11 offset:0
    ds_read_b128 v[72:75], v12 offset:0
    ds_read_b128 v[76:79], v13 offset:0
    ds_read_b128 v[80:83], v10 offset:256
    ds_read_b128 v[84:87], v11 offset:256
    ds_read_b128 v[88:91], v12 offset:256
    ds_read_b128 v[92:95], v13 offset:256
    ds_read_b128 v[96:99], v10 offset:512
    ds_read_b128 v[100:103], v11 offset:512
    ds_read_b128 v[104:107], v12 offset:512
    ds_read_b128 v[108:111], v13 offset:512
    ds_read_b128 v[112:115], v10 offset:768
    ds_read_b128 v[116:119], v11 offset:768
    ds_read_b128 v[120:123], v12 offset:768
    ds_read_b128 v[124:127], v13 offset:768
    ds_read_b128 v[128:131], v18 offset:0
    ds_read_b128 v[132:135], v19 offset:0
    ds_read_b128 v[136:139], v20 offset:0
    ds_read_b128 v[140:143], v21 offset:0
    ds_read_b128 v[144:147], v18 offset:256
    ds_read_b128 v[148:151], v19 offset:256
    ds_read_b128 v[152:155], v20 offset:256
    ds_read_b128 v[156:159], v21 offset:256
    ds_read_b128 v[160:163], v18 offset:512
    ds_read_b128 v[164:167], v19 offset:512
    ds_read_b128 v[168:171], v20 offset:512
    ds_read_b128 v[172:175], v21 offset:512
    ds_read_b128 v[176:179], v18 offset:768
    ds_read_b128 v[180:183], v19 offset:768
    ds_read_b128 v[184:187], v20 offset:768
    ds_read_b128 v[188:191], v21 offset:768
    s_waitcnt lgkmcnt(0)
    s_add_u32 s60, s59, 1
    s_xor_b32 s61, s59, 0x9e3779b9
    s_branch L_B1
L_qawave:
    s_setprio 2
    s_lshl_b32 s64, s90, 13
    s_add_u32 s64, s64, 65536
    s_add_u32 s67, s64, 4096
    s_lshl_b32 s65, s91, 19
    s_lshl_b32 s66, s90, 8
    s_add_u32 s65, s65, s66
    s_cmp_eq_u32 s3, 6
    s_mov_b32 s68, 114688
    s_cselect_b32 s68, 131072, s68
    v_add_u32 v16, 0, v3
    v_xor_b32 v16, v16, v2
    v_lshlrev_b32 v16, 4, v16
    v_lshl_add_u32 v44, v3, 13, v16
    v_add_u32 v16, 4, v3
    v_xor_b32 v16, v16, v2
    v_lshlrev_b32 v16, 4, v16
    v_lshl_add_u32 v45, v3, 13, v16
    v_add_u32 v16, 8, v3
    v_xor_b32 v16, v16, v2
    v_lshlrev_b32 v16, 4, v16
    v_lshl_add_u32 v46, v3, 13, v16
    v_add_u32 v16, 12, v3
    v_xor_b32 v16, v16, v2
    v_lshlrev_b32 v16, 4, v16
    v_lshl_add_u32 v47, v3, 13, v16
    s_barrier
    v_lshlrev_b32 v7, 7, v1
    s_bfe_u32 s69, s3, 0x10001
    s_lshl_b32 s69, s69, 6
    s_add_u32 s69, s69, s64
    buffer_load_dword v60, v7, s[48:51], s69 offen sc1
    s_add_u32 s66, s65, 0
    s_add_u32 s69, s68, 0
    s_mov_b32 m0, s69
    s_nop 0
    buffer_load_dwordx4 v44, s[16:19], s66 offen nt lds
    s_add_u32 s66, s65, 32768
    s_add_u32 s69, s68, 1024
    s_mov_b32 m0, s69
    s_nop 0
    buffer_load_dwordx4 v45, s[16:19], s66 offen nt lds
    s_add_u32 s66, s65, 65536
    s_add_u32 s69, s68, 2048
    s_mov_b32 m0, s69
    s_nop 0
    buffer_load_dwordx4 v46, s[16:19], s66 offen nt lds
    s_add_u32 s66, s65, 98304
    s_add_u32 s69, s68, 3072
    s_mov_b32 m0, s69
    s_nop 0
    buffer_load_dwordx4 v47, s[16:19], s66 offen nt lds
    s_add_u32 s66, s65, 131072
    s_add_u32 s69, s68, 4096
    s_mov_b32 m0, s69
    s_nop 0
    buffer_load_dwordx4 v44, s[16:19], s66 offen nt lds
    s_add_u32 s66, s65, 163840
    s_add_u32 s69, s68, 5120
    s_mov_b32 m0, s69
    s_nop 0
    buffer_load_dwordx4 v45, s[16:19], s66 offen nt lds
    s_add_u32 s66, s65, 196608
    s_add_u32 s69, s68, 6144
    s_mov_b32 m0, s69
    s_nop 0
    buffer_load_dwordx4 v46, s[16:19], s66 offen nt lds
    s_add_u32 s66, s65, 229376
    s_add_u32 s69, s68, 7168
    s_mov_b32 m0, s69
    s_nop 0
    buffer_load_dwordx4 v47, s[16:19], s66 offen nt lds
    s_add_u32 s66, s65, 262144
    s_add_u32 s69, s68, 8192
    s_mov_b32 m0, s69
    s_nop 0
    buffer_load_dwordx4 v44, s[16:19], s66 offen nt lds
    s_add_u32 s66, s65, 294912
    s_add_u32 s69, s68, 9216
    s_mov_b32 m0, s69
    s_nop 0
    buffer_load_dwordx4 v45, s[16:19], s66 offen nt lds
    s_add_u32 s66, s65, 327680
    s_add_u32 s69, s68, 10240
    s_mov_b32 m0, s69
    s_nop 0
    buffer_load_dwordx4 v46, s[16:19], s66 offen nt lds
    s_add_u32 s66, s65, 360448
    s_add_u32 s69, s68, 11264
    s_mov_b32 m0, s69
    s_nop 0
    buffer_load_dwordx4 v47, s[16:19], s66 offen nt lds
    s_add_u32 s66, s65, 393216
    s_add_u32 s69, s68, 12288
    s_mov_b32 m0, s69
    s_nop 0
    buffer_load_dwordx4 v44, s[16:19], s66 offen nt lds
    s_add_u32 s66, s65, 425984
    s_add_u32 s69, s68, 13312
    s_mov_b32 m0, s69
    s_nop 0
    buffer_load_dwordx4 v45, s[16:19], s66 offen nt lds
    s_add_u32 s66, s65, 458752
    s_add_u32 s69, s68, 14336
    s_mov_b32 m0, s69
    s_nop 0
    buffer_load_dwordx4 v46, s[16:19], s66 offen nt lds
    s_add_u32 s66, s65, 491520
    s_add_u32 s69, s68, 15360
    s_mov_b32 m0, s69
    s_nop 0
    buffer_load_dwordx4 v47, s[16:19], s66 offen nt lds
    v_add_u32 v16, 0, v3
    v_xor_b32 v16, v16, v2
    v_lshlrev_b32 v16, 4, v16
    v_lshl_add_u32 v16, v2, 8, v16
    v_add_u32 v44, s68, v16
    v_add_u32 v16, 4, v3
    v_xor_b32 v16, v16, v2
    v_lshlrev_b32 v16, 4, v16
    v_lshl_add_u32 v16, v2, 8, v16
    v_add_u32 v45, s68, v16
    v_add_u32 v16, 8, v3
    v_xor_b32 v16, v16, v2
    v_lshlrev_b32 v16, 4, v16
    v_lshl_add_u32 v16, v2, 8, v16
    v_add_u32 v46, s68, v16
    v_add_u32 v16, 12, v3
    v_xor_b32 v16, v16, v2
    v_lshlrev_b32 v16, 4, v16
    v_lshl_add_u32 v16, v2, 8, v16
    v_add_u32 v47, s68, v16
    v_and_b32 v17, 1, v3
    v_lshlrev_b32 v17, 1, v17
    v_lshrrev_b32 v18, 1, v3
    v_add_u32 v17, v17, v18
    v_lshl_add_u32 v17, v2, 2, v17
    v_lshlrev_b32 v17, 2, v17
    v_add_u32 v56, 151552, v17
    v_lshlrev_b32 v18, 4, v3
    v_add_u32 v57, 151552, v18
    s_waitcnt lgkmcnt(0)
    s_add_u32 s60, s59, 1
    s_xor_b32 s61, s59, 0x9e3779b9
    s_waitcnt vmcnt(0)
    ds_read_b128 v[128:131], v44 offset:0
    ds_read_b128 v[132:135], v45 offset:0
    ds_read_b128 v[136:139], v46 offset:0
    ds_read_b128 v[140:143], v47 offset:0
    ds_read_b128 v[144:147], v44 offset:4096
    ds_read_b128 v[148:151], v45 offset:4096
    ds_read_b128 v[152:155], v46 offset:4096
    ds_read_b128 v[156:159], v47 offset:4096
    ds_read_b128 v[160:163], v44 offset:8192
    ds_read_b128 v[164:167], v45 offset:8192
    ds_read_b128 v[168:171], v46 offset:8192
    ds_read_b128 v[172:175], v47 offset:8192
    ds_read_b128 v[176:179], v44 offset:12288
    ds_read_b128 v[180:183], v45 offset:12288
    ds_read_b128 v[184:187], v46 offset:12288
    ds_read_b128 v[188:191], v47 offset:12288
    s_cmp_eq_u32 s3, 6
    s_cbranch_scc1 L_qa6
    s_waitcnt lgkmcnt(0)
    v_mov_b32 v9, 152320
    s_mov_b32 s79, 0
Lw_13:

    ds_read_b32 v8, v9 offset:16
    s_waitcnt lgkmcnt(0)
    v_readfirstlane_b32 s78, v8
    s_add_u32 s79, s79, 1
    s_cmp_gt_u32 s79, 2000000
    s_cbranch_scc1 Lx_14
    s_cmp_eq_u32 s78, -1
    s_cbranch_scc1 Lw_13
Lx_14:
    s_branch L_qaj
L_qa6:
    s_sleep 1
    s_mov_b32 s79, 0
    s_mov_b64 exec, -1
    buffer_load_dwordx4 v[64:67], v6, s[48:51], s64 offen offset:0 sc1
    buffer_load_dwordx4 v[68:71], v6, s[48:51], s64 offen offset:1024 sc1
    buffer_load_dwordx4 v[72:75], v6, s[48:51], s64 offen offset:2048 sc1
    buffer_load_dwordx4 v[76:79], v6, s[48:51], s64 offen offset:3072 sc1
    buffer_load_dwordx4 v[80:83], v6, s[48:51], s67 offen offset:0 sc1
    buffer_load_dwordx4 v[84:87], v6, s[48:51], s67 offen offset:1024 sc1
    buffer_load_dwordx4 v[88:91], v6, s[48:51], s67 offen offset:2048 sc1
    buffer_load_dwordx4 v[92:95], v6, s[48:51], s67 offen offset:3072 sc1
    s_branch Lc_s1_17
Lp_s1_15:
    s_mov_b64 exec, s[80:81]
    s_cbranch_execz Ls_18
    buffer_load_dwordx4 v[64:67], v6, s[48:51], s64 offen offset:0 sc1
Ls_18:
    s_mov_b64 exec, s[82:83]
    s_cbranch_execz Ls_19
    buffer_load_dwordx4 v[68:71], v6, s[48:51], s64 offen offset:1024 sc1
Ls_19:
    s_mov_b64 exec, s[84:85]
    s_cbranch_execz Ls_20
    buffer_load_dwordx4 v[72:75], v6, s[48:51], s64 offen offset:2048 sc1
Ls_20:
    s_mov_b64 exec, s[86:87]
    s_cbranch_execz Ls_21
    buffer_load_dwordx4 v[76:79], v6, s[48:51], s64 offen offset:3072 sc1
Ls_21:
    s_mov_b64 exec, s[88:89]
    s_cbranch_execz Ls_22
    buffer_load_dwordx4 v[80:83], v6, s[48:51], s67 offen offset:0 sc1
Ls_22:
    s_mov_b64 exec, s[68:69]
    s_cbranch_execz Ls_23
    buffer_load_dwordx4 v[84:87], v6, s[48:51], s67 offen offset:1024 sc1
Ls_23:
    s_mov_b64 exec, s[70:71]
    s_cbranch_execz Ls_24
    buffer_load_dwordx4 v[88:91], v6, s[48:51], s67 offen offset:2048 sc1
Ls_24:
    s_mov_b64 exec, s[72:73]
    s_cbranch_execz Ls_25
    buffer_load_dwordx4 v[92:95], v6, s[48:51], s67 offen offset:3072 sc1
Ls_25:
    s_mov_b64 exec, -1
Lc_s1_17:
    s_waitcnt vmcnt(0)
    v_cmp_ne_u64 s[80:81], v[66:67], s[60:61]
    v_cmp_ne_u64 s[82:83], v[70:71], s[60:61]
    v_cmp_ne_u64 s[84:85], v[74:75], s[60:61]
    v_cmp_ne_u64 s[86:87], v[78:79], s[60:61]
    v_cmp_ne_u64 s[88:89], v[82:83], s[60:61]
    v_cmp_ne_u64 s[68:69], v[86:87], s[60:61]
    v_cmp_ne_u64 s[70:71], v[90:91], s[60:61]
    v_cmp_ne_u64 s[72:73], v[94:95], s[60:61]
    s_mov_b64 s[76:77], s[80:81]
    s_or_b64 s[76:77], s[76:77], s[82:83]
    s_or_b64 s[76:77], s[76:77], s[84:85]
    s_or_b64 s[76:77], s[76:77], s[86:87]
    s_or_b64 s[76:77], s[76:77], s[88:89]
    s_or_b64 s[76:77], s[76:77], s[68:69]
    s_or_b64 s[76:77], s[76:77], s[70:71]
    s_or_b64 s[76:77], s[76:77], s[72:73]
    s_add_u32 s79, s79, 1
    s_cmp_gt_u32 s79, 100000
    s_cbranch_scc1 Lq_s1_16
    s_cmp_lg_u64 s[76:77], 0
    s_cbranch_scc1 Lp_s1_15
Lq_s1_16:
    s_mov_b64 exec, -1
    v_add_f32 v16, v64, v68
    v_add_f32 v17, v65, v69
    v_add_f32 v18, v72, v76
    v_add_f32 v19, v73, v77
    v_add_f32 v20, v80, v84
    v_add_f32 v21, v81, v85
    v_add_f32 v22, v88, v92
    v_add_f32 v23, v89, v93
    v_add_f32 v16, v16, v18
    v_add_f32 v17, v17, v19
    v_add_f32 v20, v20, v22
    v_add_f32 v21, v21, v23
    v_add_f32 v16, v16, v20
    v_add_f32 v17, v17, v21
    v_cvt_pk_bf16_f32 v16, v16, v17
    ds_write_b32 v56, v16
    s_waitcnt lgkmcnt(0)
    v_mov_b32 v9, 152320
    v_mov_b32 v8, 1
    ds_write_b32 v9, v8 offset:16
L_qaj:
    ds_read_b128 v[192:195], v57 offset:0
    ds_read_b128 v[196:199], v57 offset:64
    ds_read_b128 v[200:203], v57 offset:128
    ds_read_b128 v[204:207], v57 offset:192
    s_mov_b32 s66, 0x3e0293ee
    s_lshl_b32 s64, s90, 11
    s_lshl_b32 s65, s91, 8
    s_add_u32 s64, s64, s65
    s_add_u32 s64, s64, 327680
    v_mov_b32 v226, s60
    v_mov_b32 v227, s61
    v_lshlrev_b32 v16, 6, v3
    v_lshl_add_u32 v16, v2, 4, v16
    v_cmp_eq_u32 s[68:69], 1, v2
    v_cmp_eq_u32 s[70:71], 2, v2
    v_cmp_eq_u32 s[72:73], 3, v2
    s_mov_b32 s74, 0x000f000f
    s_mov_b32 s75, 0x000f000f
    s_waitcnt lgkmcnt(0)
    v_mfma_f32_16x16x32_bf16 v[208:211], v[128:131], v[192:195], 0
    v_mfma_f32_16x16x32_bf16 v[212:215], v[144:147], v[192:195], 0
    v_mfma_f32_16x16x32_bf16 v[216:219], v[160:163], v[192:195], 0
    v_mfma_f32_16x16x32_bf16 v[220:223], v[176:179], v[192:195], 0
    v_mfma_f32_16x16x32_bf16 v[208:211], v[132:135], v[196:199], v[208:211]
    v_mfma_f32_16x16x32_bf16 v[212:215], v[148:151], v[196:199], v[212:215]
    v_mfma_f32_16x16x32_bf16 v[216:219], v[164:167], v[196:199], v[216:219]
    v_mfma_f32_16x16x32_bf16 v[220:223], v[180:183], v[196:199], v[220:223]
    v_mfma_f32_16x16x32_bf16 v[208:211], v[136:139], v[200:203], v[208:211]
    v_mfma_f32_16x16x32_bf16 v[212:215], v[152:155], v[200:203], v[212:215]
    v_mfma_f32_16x16x32_bf16 v[216:219], v[168:171], v[200:203], v[216:219]
    v_mfma_f32_16x16x32_bf16 v[220:223], v[184:187], v[200:203], v[220:223]
    v_mfma_f32_16x16x32_bf16 v[208:211], v[140:143], v[204:207], v[208:211]
    v_mfma_f32_16x16x32_bf16 v[212:215], v[156:159], v[204:207], v[212:215]
    v_mfma_f32_16x16x32_bf16 v[216:219], v[172:175], v[204:207], v[216:219]
    v_mfma_f32_16x16x32_bf16 v[220:223], v[188:191], v[204:207], v[220:223]
    s_nop 5
    v_cndmask_b32 v208, v208, v212, s[68:69]
    v_cndmask_b32 v209, v209, v213, s[68:69]
    v_cndmask_b32 v210, v210, v214, s[68:69]
    v_cndmask_b32 v211, v211, v215, s[68:69]
    v_cndmask_b32 v208, v208, v216, s[70:71]
    v_cndmask_b32 v209, v209, v217, s[70:71]
    v_cndmask_b32 v210, v210, v218, s[70:71]
    v_cndmask_b32 v211, v211, v219, s[70:71]
    v_cndmask_b32 v208, v208, v220, s[72:73]
    v_cndmask_b32 v209, v209, v221, s[72:73]
    v_cndmask_b32 v210, v210, v222, s[72:73]
    v_cndmask_b32 v211, v211, v223, s[72:73]
    v_mul_f32 v208, s66, v208
    v_mul_f32 v209, s66, v209
    v_mul_f32 v210, s66, v210
    v_mul_f32 v211, s66, v211
    v_cvt_pk_bf16_f32 v224, v208, v209
    v_cvt_pk_bf16_f32 v225, v210, v211
    s_mov_b64 exec, s[74:75]
    buffer_store_dwordx4 v[224:227], v16, s[48:51], s64 offen sc1
    s_mov_b64 exec, -1
    s_setprio 0
    s_cmp_eq_u32 s3, 6
    s_cbranch_scc1 L_qa6b
    v_mov_b32 v9, 152320
    v_mov_b32 v8, 1
    ds_write_b32 v9, v8 offset:12
    v_mov_b32 v9, 152320
    v_mov_b32 v8, 1
    ds_write_b32 v9, v8 offset:20
    s_branch L_qaj2
L_qa6b:
    v_mov_b32 v9, 152320
    v_mov_b32 v8, 1
    ds_write_b32 v9, v8 offset:4
    v_mov_b32 v9, 152320
    v_mov_b32 v8, 1
    ds_write_b32 v9, v8 offset:8
L_qaj2:
L_s2:
    s_lshl_b32 s64, s57, 15
    s_and_b32 s65, s3, 3
    s_lshl_b32 s66, s65, 13
    s_add_u32 s64, s64, s66
    s_add_u32 s64, s64, 327680
    s_add_u32 s67, s64, 4096
    v_and_b32 v10, 3, v1
    v_lshlrev_b32 v10, 2, v10
    v_bfe_u32 v11, v1, 2, 2
    v_add_u32 v10, v10, v11
    v_lshl_add_u32 v10, v3, 4, v10
    v_lshrrev_b32 v7, 1, v10
    v_and_b32 v10, 1, v10
    v_lshlrev_b32 v10, 3, v10
    s_lshl_b32 s66, s65, 2
    s_add_u32 s66, s66, 0
    s_and_b32 s68, s66, 7
    s_lshl_b32 s68, s68, 1
    s_lshl_b32 s66, s66, 10
    s_add_u32 s66, s66, 131072
    v_xor_b32 v11, s68, v7
    v_lshl_add_u32 v11, v11, 4, v10
    v_add_u32 v28, s66, v11
    s_lshl_b32 s66, s65, 2
    s_add_u32 s66, s66, 1
    s_and_b32 s68, s66, 7
    s_lshl_b32 s68, s68, 1
    s_lshl_b32 s66, s66, 10
    s_add_u32 s66, s66, 131072
    v_xor_b32 v11, s68, v7
    v_lshl_add_u32 v11, v11, 4, v10
    v_add_u32 v29, s66, v11
    s_lshl_b32 s66, s65, 2
    s_add_u32 s66, s66, 2
    s_and_b32 s68, s66, 7
    s_lshl_b32 s68, s68, 1
    s_lshl_b32 s66, s66, 10
    s_add_u32 s66, s66, 131072
    v_xor_b32 v11, s68, v7
    v_lshl_add_u32 v11, v11, 4, v10
    v_add_u32 v30, s66, v11
    s_lshl_b32 s66, s65, 2
    s_add_u32 s66, s66, 3
    s_and_b32 s68, s66, 7
    s_lshl_b32 s68, s68, 1
    s_lshl_b32 s66, s66, 10
    s_add_u32 s66, s66, 131072
    v_xor_b32 v11, s68, v7
    v_lshl_add_u32 v11, v11, 4, v10
    v_add_u32 v31, s66, v11
    v_lshrrev_b32 v7, 2, v1
    v_and_b32 v8, 7, v7
    v_lshlrev_b32 v8, 1, v8
    v_bfe_u32 v9, v1, 1, 1
    s_lshl_b32 s66, s65, 4
    v_add_u32 v9, s66, v9
    v_xor_b32 v9, v9, v8
    v_and_b32 v18, 1, v1
    v_lshlrev_b32 v18, 3, v18
    v_lshl_add_u32 v18, v7, 10, v18
    v_lshl_add_u32 v18, v9, 4, v18
    v_xor_b32 v32, 0, v18
    v_add_u32 v33, 0x10000, v32
    v_xor_b32 v34, 32, v18
    v_add_u32 v35, 0x10000, v34
    v_xor_b32 v36, 64, v18
    v_add_u32 v37, 0x10000, v36
    v_xor_b32 v38, 96, v18
    v_add_u32 v39, 0x10000, v38
    v_xor_b32 v40, 128, v18
    v_add_u32 v41, 0x10000, v40
    v_xor_b32 v42, 160, v18
    v_add_u32 v43, 0x10000, v42
    v_xor_b32 v44, 192, v18
    v_add_u32 v45, 0x10000, v44
    v_xor_b32 v46, 224, v18
    v_add_u32 v47, 0x10000, v46
    v_mov_b32 v9, 152320
    s_mov_b32 s79, 0
Lw_26:

    ds_read_b32 v8, v9 offset:8
    s_waitcnt lgkmcnt(0)
    v_readfirstlane_b32 s78, v8
    s_add_u32 s79, s79, 1
    s_cmp_gt_u32 s79, 2000000
    s_cbranch_scc1 Lx_27
    s_cmp_eq_u32 s78, -1
    s_cbranch_scc1 Lw_26
Lx_27:
    v_mov_b32 v9, 152320
    s_mov_b32 s79, 0
Lw_28:

    ds_read_b32 v8, v9 offset:12
    s_waitcnt lgkmcnt(0)
    v_readfirstlane_b32 s78, v8
    s_add_u32 s79, s79, 1
    s_cmp_gt_u32 s79, 2000000
    s_cbranch_scc1 Lx_29
    s_cmp_eq_u32 s78, -1
    s_cbranch_scc1 Lw_28
Lx_29:
    s_cmp_eq_u32 s57, 1
    s_cbranch_scc1 L_nogap
    s_sleep 10
L_nogap:
    s_lshl_b32 s65, s52, 9
    s_add_u32 s65, s65, 4096
    v_and_b32 v7, 31, v1
    v_lshlrev_b32 v7, 4, v7
    buffer_load_dwordx4 v[56:59], v7, s[48:51], s65 offen sc1
    s_mov_b32 s79, 0
    s_mov_b64 exec, -1
    buffer_load_dwordx4 v[64:67], v6, s[48:51], s64 offen offset:0 sc1
    buffer_load_dwordx4 v[68:71], v6, s[48:51], s64 offen offset:1024 sc1
    buffer_load_dwordx4 v[72:75], v6, s[48:51], s64 offen offset:2048 sc1
    buffer_load_dwordx4 v[76:79], v6, s[48:51], s64 offen offset:3072 sc1
    buffer_load_dwordx4 v[80:83], v6, s[48:51], s67 offen offset:0 sc1
    buffer_load_dwordx4 v[84:87], v6, s[48:51], s67 offen offset:1024 sc1
    buffer_load_dwordx4 v[88:91], v6, s[48:51], s67 offen offset:2048 sc1
    buffer_load_dwordx4 v[92:95], v6, s[48:51], s67 offen offset:3072 sc1
    s_branch Lc_s2_32
Lp_s2_30:
    s_mov_b64 exec, s[80:81]
    s_cbranch_execz Ls_33
    buffer_load_dwordx4 v[64:67], v6, s[48:51], s64 offen offset:0 sc1
Ls_33:
    s_mov_b64 exec, s[82:83]
    s_cbranch_execz Ls_34
    buffer_load_dwordx4 v[68:71], v6, s[48:51], s64 offen offset:1024 sc1
Ls_34:
    s_mov_b64 exec, s[84:85]
    s_cbranch_execz Ls_35
    buffer_load_dwordx4 v[72:75], v6, s[48:51], s64 offen offset:2048 sc1
Ls_35:
    s_mov_b64 exec, s[86:87]
    s_cbranch_execz Ls_36
    buffer_load_dwordx4 v[76:79], v6, s[48:51], s64 offen offset:3072 sc1
Ls_36:
    s_mov_b64 exec, s[88:89]
    s_cbranch_execz Ls_37
    buffer_load_dwordx4 v[80:83], v6, s[48:51], s67 offen offset:0 sc1
Ls_37:
    s_mov_b64 exec, s[68:69]
    s_cbranch_execz Ls_38
    buffer_load_dwordx4 v[84:87], v6, s[48:51], s67 offen offset:1024 sc1
Ls_38:
    s_mov_b64 exec, s[70:71]
    s_cbranch_execz Ls_39
    buffer_load_dwordx4 v[88:91], v6, s[48:51], s67 offen offset:2048 sc1
Ls_39:
    s_mov_b64 exec, s[72:73]
    s_cbranch_execz Ls_40
    buffer_load_dwordx4 v[92:95], v6, s[48:51], s67 offen offset:3072 sc1
Ls_40:
    s_mov_b64 exec, -1
Lc_s2_32:
    s_waitcnt vmcnt(0)
    v_cmp_ne_u64 s[80:81], v[66:67], s[60:61]
    v_cmp_ne_u64 s[82:83], v[70:71], s[60:61]
    v_cmp_ne_u64 s[84:85], v[74:75], s[60:61]
    v_cmp_ne_u64 s[86:87], v[78:79], s[60:61]
    v_cmp_ne_u64 s[88:89], v[82:83], s[60:61]
    v_cmp_ne_u64 s[68:69], v[86:87], s[60:61]
    v_cmp_ne_u64 s[70:71], v[90:91], s[60:61]
    v_cmp_ne_u64 s[72:73], v[94:95], s[60:61]
    s_mov_b64 s[76:77], s[80:81]
    s_or_b64 s[76:77], s[76:77], s[82:83]
    s_or_b64 s[76:77], s[76:77], s[84:85]
    s_or_b64 s[76:77], s[76:77], s[86:87]
    s_or_b64 s[76:77], s[76:77], s[88:89]
    s_or_b64 s[76:77], s[76:77], s[68:69]
    s_or_b64 s[76:77], s[76:77], s[70:71]
    s_or_b64 s[76:77], s[76:77], s[72:73]
    s_add_u32 s79, s79, 1
    s_cmp_gt_u32 s79, 100000
    s_cbranch_scc1 Lq_s2_31
    s_cmp_lg_u64 s[76:77], 0
    s_cbranch_scc1 Lp_s2_30
Lq_s2_31:
    s_mov_b64 exec, -1
    ds_write_b64 v28, v[64:65] offset:0
    ds_write_b64 v28, v[68:69] offset:512
    ds_write_b64 v29, v[72:73] offset:0
    ds_write_b64 v29, v[76:77] offset:512
    ds_write_b64 v30, v[80:81] offset:0
    ds_write_b64 v30, v[84:85] offset:512
    ds_write_b64 v31, v[88:89] offset:0
    ds_write_b64 v31, v[92:93] offset:512
    v_cmp_ne_u64 s[76:77], v[58:59], s[60:61]
    v_cmp_ne_u32 vcc, s95, v56
    s_or_b64 s[74:75], vcc, s[76:77]
    s_cselect_b32 s62, 0, 1
L_nos1:
    s_cmp_lg_u32 s3, 7
    s_cbranch_scc1 L_B1
    v_mov_b32 v9, 152320
    v_mov_b32 v8, s62
    ds_write_b32 v9, v8 offset:0
L_B1:
    s_waitcnt lgkmcnt(0)
    s_barrier
    s_cmp_ge_u32 s3, 4
    s_cbranch_scc1 L_vw
    v_mov_b32 v22, 152320
    ds_read_b32 v20, v22
    ds_read_b128 v[32:35], v14 offset:0
    ds_read_b128 v[36:39], v15 offset:0
    ds_read_b128 v[40:43], v16 offset:0
    ds_read_b128 v[44:47], v17 offset:0
    ds_read_b128 v[48:51], v14 offset:256
    ds_read_b128 v[52:55], v15 offset:256
    ds_read_b128 v[56:59], v16 offset:256
    ds_read_b128 v[60:63], v17 offset:256
    s_waitcnt lgkmcnt(8)
    v_readfirstlane_b32 s62, v20
    v_lshlrev_b32 v7, 4, v2
    v_add_u32 v7, 151808, v7
    s_lshl_b32 s65, s3, 2
    v_add_u32 v8, s65, v7
    s_lshl_b32 s65, s3, 10
    s_add_u32 s65, s65, 147456
    v_add_u32 v9, s65, v6
    v_lshlrev_b32 v21, 6, v2
    v_lshl_add_u32 v21, v3, 2, v21
    s_lshl_b32 s65, s3, 4
    s_add_u32 s65, s65, 157184
    v_add_u32 v21, s65, v21
    s_waitcnt lgkmcnt(7)
    v_mfma_f32_16x16x32_bf16 v[224:227], v[64:67], v[32:35], 0
    v_mfma_f32_16x16x32_bf16 v[228:231], v[128:131], v[32:35], 0
    ds_read_b128 v[32:35], v14 offset:512
    s_cmp_lt_u32 s53, 16
    s_cbranch_scc1 Lnw_41
    s_cmp_eq_u32 s62, 0
    s_cbranch_scc1 Lnw_42
    s_lshl_b32 s70, s52, 5
    s_and_b32 s71, s53, 15
    s_add_u32 s70, s70, s71
    s_lshr_b32 s71, s3, 2
    s_lshl_b32 s71, s71, 4
    s_add_u32 s70, s70, s71
    s_lshl_b32 s71, s70, 14
    s_and_b32 s69, s3, 3
    s_lshl_b32 s72, s69, 12
    s_add_u32 s71, s71, s72
    s_add_u32 s71, s71, 2097152
    v_lshlrev_b32 v12, 6, v1
    buffer_load_dword v22, v12, s[48:51], s71 offen
    s_lshl_b32 s71, s70, 10
    s_add_u32 s71, s71, 524288
    s_lshl_b32 s72, s52, 13
    s_lshl_b32 s73, s55, 10
    s_add_u32 s72, s72, s73
    s_add_u32 s72, s72, 1048576
    s_cmp_eq_u32 s69, 0
    s_cselect_b32 s71, s71, s72
    v_and_b32 v12, 0x3c0, v12
    buffer_load_dword v22, v12, s[48:51], s71 offen
    s_branch Lnw_42
Lnw_41:
    v_lshlrev_b32 v12, 13, v3
    v_lshl_add_u32 v12, v2, 4, v12
    s_and_b32 s70, s53, 3
    s_lshl_b32 s70, s70, 20
    s_lshr_b32 s71, s53, 2
    s_lshl_b32 s73, s52, 2
    s_add_u32 s71, s71, s73
    s_lshl_b32 s71, s71, 8
    s_add_u32 s70, s70, s71
    s_lshl_b32 s71, s3, 17
    s_add_u32 s70, s70, s71
    s_add_u32 s71, s70, 0
    buffer_load_dwordx4 v[192:195], v12, s[20:23], s71 offen
    s_add_u32 s71, s70, 32768
    buffer_load_dwordx4 v[196:199], v12, s[20:23], s71 offen
    s_add_u32 s71, s70, 65536
    buffer_load_dwordx4 v[200:203], v12, s[20:23], s71 offen
    s_add_u32 s71, s70, 98304
    buffer_load_dwordx4 v[204:207], v12, s[20:23], s71 offen
Lnw_42:
    s_waitcnt lgkmcnt(7)
    v_mfma_f32_16x16x32_bf16 v[224:227], v[68:71], v[36:39], v[224:227]
    v_mfma_f32_16x16x32_bf16 v[228:231], v[132:135], v[36:39], v[228:231]
    ds_read_b128 v[36:39], v15 offset:512
    s_waitcnt lgkmcnt(7)
    v_mfma_f32_16x16x32_bf16 v[224:227], v[72:75], v[40:43], v[224:227]
    v_mfma_f32_16x16x32_bf16 v[228:231], v[136:139], v[40:43], v[228:231]
    ds_read_b128 v[40:43], v16 offset:512
    s_waitcnt lgkmcnt(7)
    v_mfma_f32_16x16x32_bf16 v[224:227], v[76:79], v[44:47], v[224:227]
    v_mfma_f32_16x16x32_bf16 v[228:231], v[140:143], v[44:47], v[228:231]
    ds_read_b128 v[44:47], v17 offset:512
    s_waitcnt lgkmcnt(7)
    v_mfma_f32_16x16x32_bf16 v[224:227], v[80:83], v[48:51], v[224:227]
    v_mfma_f32_16x16x32_bf16 v[228:231], v[144:147], v[48:51], v[228:231]
    ds_read_b128 v[48:51], v14 offset:768
    s_waitcnt lgkmcnt(7)
    v_mfma_f32_16x16x32_bf16 v[224:227], v[84:87], v[52:55], v[224:227]
    v_mfma_f32_16x16x32_bf16 v[228:231], v[148:151], v[52:55], v[228:231]
    ds_read_b128 v[52:55], v15 offset:768
    s_waitcnt lgkmcnt(7)
    v_mfma_f32_16x16x32_bf16 v[224:227], v[88:91], v[56:59], v[224:227]
    v_mfma_f32_16x16x32_bf16 v[228:231], v[152:155], v[56:59], v[228:231]
    ds_read_b128 v[56:59], v16 offset:768
    s_waitcnt lgkmcnt(7)
    v_mfma_f32_16x16x32_bf16 v[224:227], v[92:95], v[60:63], v[224:227]
    v_mfma_f32_16x16x32_bf16 v[228:231], v[156:159], v[60:63], v[228:231]
    ds_read_b128 v[60:63], v17 offset:768
    s_waitcnt lgkmcnt(7)
    v_mfma_f32_16x16x32_bf16 v[224:227], v[96:99], v[32:35], v[224:227]
    v_mfma_f32_16x16x32_bf16 v[228:231], v[160:163], v[32:35], v[228:231]
    s_waitcnt lgkmcnt(6)
    v_mfma_f32_16x16x32_bf16 v[224:227], v[100:103], v[36:39], v[224:227]
    v_mfma_f32_16x16x32_bf16 v[228:231], v[164:167], v[36:39], v[228:231]
    s_waitcnt lgkmcnt(5)
    v_mfma_f32_16x16x32_bf16 v[224:227], v[104:107], v[40:43], v[224:227]
    v_mfma_f32_16x16x32_bf16 v[228:231], v[168:171], v[40:43], v[228:231]
    s_waitcnt lgkmcnt(4)
    v_mfma_f32_16x16x32_bf16 v[224:227], v[108:111], v[44:47], v[224:227]
    v_mfma_f32_16x16x32_bf16 v[228:231], v[172:175], v[44:47], v[228:231]
    s_waitcnt lgkmcnt(3)
    v_mfma_f32_16x16x32_bf16 v[224:227], v[112:115], v[48:51], v[224:227]
    v_mfma_f32_16x16x32_bf16 v[228:231], v[176:179], v[48:51], v[228:231]
    s_waitcnt lgkmcnt(2)
    v_mfma_f32_16x16x32_bf16 v[224:227], v[116:119], v[52:55], v[224:227]
    v_mfma_f32_16x16x32_bf16 v[228:231], v[180:183], v[52:55], v[228:231]
    s_waitcnt lgkmcnt(1)
    v_mfma_f32_16x16x32_bf16 v[224:227], v[120:123], v[56:59], v[224:227]
    v_mfma_f32_16x16x32_bf16 v[228:231], v[184:187], v[56:59], v[228:231]
    s_waitcnt lgkmcnt(0)
    v_mfma_f32_16x16x32_bf16 v[224:227], v[124:127], v[60:63], v[224:227]
    v_mfma_f32_16x16x32_bf16 v[228:231], v[188:191], v[60:63], v[228:231]
    s_nop 6
    v_max3_f32 v24, v224, v225, v226
    v_max3_f32 v24, v24, v227, v228
    v_max3_f32 v24, v24, v229, v230
    v_max_f32 v24, v24, v231
    v_mov_b32 v25, v24
    s_nop 1
    v_permlane16_swap_b32 v24, v25
    v_max_f32 v24, v24, v25
    v_mov_b32 v25, v24
    s_nop 1
    v_permlane32_swap_b32 v24, v25
    v_max_f32 v24, v24, v25
    ds_write_b32 v8, v24
    s_mov_b32 s79, 0
Lmx_43:
    ds_read_b128 v[24:27], v7
    s_add_u32 s79, s79, 1
    s_waitcnt lgkmcnt(0)
    v_max3_u32 v28, v24, v25, v26
    v_max_u32 v28, v28, v27
    v_cmp_eq_u32 vcc, -1, v28
    s_cmp_gt_u32 s79, 100000
    s_cbranch_scc1 Lmy_44
    s_cbranch_vccnz Lmx_43
Lmy_44:
    v_max3_f32 v24, v24, v25, v26
    v_max_f32 v19, v24, v27
    v_sub_f32 v224, v224, v19
    v_sub_f32 v225, v225, v19
    v_sub_f32 v226, v226, v19
    v_sub_f32 v227, v227, v19
    v_sub_f32 v228, v228, v19
    v_sub_f32 v229, v229, v19
    v_sub_f32 v230, v230, v19
    v_sub_f32 v231, v231, v19
    v_exp_f32 v224, v224
    v_exp_f32 v225, v225
    v_exp_f32 v226, v226
    v_exp_f32 v227, v227
    v_exp_f32 v228, v228
    v_exp_f32 v229, v229
    v_exp_f32 v230, v230
    v_exp_f32 v231, v231
    v_cvt_pk_bf16_f32 v24, v224, v225
    v_cvt_pk_bf16_f32 v25, v226, v227
    v_cvt_pk_bf16_f32 v26, v228, v229
    v_cvt_pk_bf16_f32 v27, v230, v231
    ds_write_b128 v9, v[24:27]
    v_add_f32 v224, v224, v225
    v_add_f32 v226, v226, v227
    v_add_f32 v228, v228, v229
    v_add_f32 v230, v230, v231
    v_add_f32 v224, v224, v226
    v_add_f32 v228, v228, v230
    v_add_f32 v224, v224, v228
    ds_write_b32 v21, v224
    s_waitcnt lgkmcnt(0)
    s_barrier
    s_barrier
    s_branch L_post
L_vw:
    ds_read_b64_tr_b16 v[64:65], v32 offset:0
    ds_read_b64_tr_b16 v[66:67], v33 offset:0
    ds_read_b64_tr_b16 v[80:81], v34 offset:0
    ds_read_b64_tr_b16 v[82:83], v35 offset:0
    ds_read_b64_tr_b16 v[96:97], v36 offset:0
    ds_read_b64_tr_b16 v[98:99], v37 offset:0
    ds_read_b64_tr_b16 v[112:113], v38 offset:0
    ds_read_b64_tr_b16 v[114:115], v39 offset:0
    ds_read_b64_tr_b16 v[128:129], v40 offset:0
    ds_read_b64_tr_b16 v[130:131], v41 offset:0
    ds_read_b64_tr_b16 v[144:145], v42 offset:0
    ds_read_b64_tr_b16 v[146:147], v43 offset:0
    ds_read_b64_tr_b16 v[160:161], v44 offset:0
    ds_read_b64_tr_b16 v[162:163], v45 offset:0
    ds_read_b64_tr_b16 v[176:177], v46 offset:0
    ds_read_b64_tr_b16 v[178:179], v47 offset:0
    ds_read_b64_tr_b16 v[68:69], v32 offset:16384
    ds_read_b64_tr_b16 v[70:71], v33 offset:16384
    ds_read_b64_tr_b16 v[84:85], v34 offset:16384
    ds_read_b64_tr_b16 v[86:87], v35 offset:16384
    ds_read_b64_tr_b16 v[100:101], v36 offset:16384
    ds_read_b64_tr_b16 v[102:103], v37 offset:16384
    ds_read_b64_tr_b16 v[116:117], v38 offset:16384
    ds_read_b64_tr_b16 v[118:119], v39 offset:16384
    ds_read_b64_tr_b16 v[132:133], v40 offset:16384
    ds_read_b64_tr_b16 v[134:135], v41 offset:16384
    ds_read_b64_tr_b16 v[148:149], v42 offset:16384
    ds_read_b64_tr_b16 v[150:151], v43 offset:16384
    ds_read_b64_tr_b16 v[164:165], v44 offset:16384
    ds_read_b64_tr_b16 v[166:167], v45 offset:16384
    ds_read_b64_tr_b16 v[180:181], v46 offset:16384
    ds_read_b64_tr_b16 v[182:183], v47 offset:16384
    ds_read_b64_tr_b16 v[72:73], v32 offset:32768
    ds_read_b64_tr_b16 v[74:75], v33 offset:32768
    ds_read_b64_tr_b16 v[88:89], v34 offset:32768
    ds_read_b64_tr_b16 v[90:91], v35 offset:32768
    ds_read_b64_tr_b16 v[104:105], v36 offset:32768
    ds_read_b64_tr_b16 v[106:107], v37 offset:32768
    ds_read_b64_tr_b16 v[120:121], v38 offset:32768
    ds_read_b64_tr_b16 v[122:123], v39 offset:32768
    ds_read_b64_tr_b16 v[136:137], v40 offset:32768
    ds_read_b64_tr_b16 v[138:139], v41 offset:32768
    ds_read_b64_tr_b16 v[152:153], v42 offset:32768
    ds_read_b64_tr_b16 v[154:155], v43 offset:32768
    ds_read_b64_tr_b16 v[168:169], v44 offset:32768
    ds_read_b64_tr_b16 v[170:171], v45 offset:32768
    ds_read_b64_tr_b16 v[184:185], v46 offset:32768
    ds_read_b64_tr_b16 v[186:187], v47 offset:32768
    ds_read_b64_tr_b16 v[76:77], v32 offset:49152
    ds_read_b64_tr_b16 v[78:79], v33 offset:49152
    ds_read_b64_tr_b16 v[92:93], v34 offset:49152
    ds_read_b64_tr_b16 v[94:95], v35 offset:49152
    ds_read_b64_tr_b16 v[108:109], v36 offset:49152
    ds_read_b64_tr_b16 v[110:111], v37 offset:49152
    ds_read_b64_tr_b16 v[124:125], v38 offset:49152
    ds_read_b64_tr_b16 v[126:127], v39 offset:49152
    ds_read_b64_tr_b16 v[140:141], v40 offset:49152
    ds_read_b64_tr_b16 v[142:143], v41 offset:49152
    ds_read_b64_tr_b16 v[156:157], v42 offset:49152
    ds_read_b64_tr_b16 v[158:159], v43 offset:49152
    ds_read_b64_tr_b16 v[172:173], v44 offset:49152
    ds_read_b64_tr_b16 v[174:175], v45 offset:49152
    ds_read_b64_tr_b16 v[188:189], v46 offset:49152
    ds_read_b64_tr_b16 v[190:191], v47 offset:49152
    s_cmp_lt_u32 s53, 16
    s_cbranch_scc1 Lnw_45
    s_cmp_eq_u32 s62, 0
    s_cbranch_scc1 Lnw_46
    s_lshl_b32 s70, s52, 5
    s_and_b32 s71, s53, 15
    s_add_u32 s70, s70, s71
    s_lshr_b32 s71, s3, 2
    s_lshl_b32 s71, s71, 4
    s_add_u32 s70, s70, s71
    s_lshl_b32 s71, s70, 14
    s_and_b32 s69, s3, 3
    s_lshl_b32 s72, s69, 12
    s_add_u32 s71, s71, s72
    s_add_u32 s71, s71, 2097152
    v_lshlrev_b32 v12, 6, v1
    buffer_load_dword v22, v12, s[48:51], s71 offen
    s_lshl_b32 s71, s70, 10
    s_add_u32 s71, s71, 524288
    s_lshl_b32 s72, s52, 13
    s_lshl_b32 s73, s55, 10
    s_add_u32 s72, s72, s73
    s_add_u32 s72, s72, 1048576
    s_cmp_eq_u32 s69, 0
    s_cselect_b32 s71, s71, s72
    v_and_b32 v12, 0x3c0, v12
    buffer_load_dword v22, v12, s[48:51], s71 offen
    s_branch Lnw_46
Lnw_45:
    v_lshlrev_b32 v12, 13, v3
    v_lshl_add_u32 v12, v2, 4, v12
    s_and_b32 s70, s53, 3
    s_lshl_b32 s70, s70, 20
    s_lshr_b32 s71, s53, 2
    s_lshl_b32 s73, s52, 2
    s_add_u32 s71, s71, s73
    s_lshl_b32 s71, s71, 8
    s_add_u32 s70, s70, s71
    s_lshl_b32 s71, s3, 17
    s_add_u32 s70, s70, s71
    s_add_u32 s71, s70, 0
    buffer_load_dwordx4 v[192:195], v12, s[20:23], s71 offen
    s_add_u32 s71, s70, 32768
    buffer_load_dwordx4 v[196:199], v12, s[20:23], s71 offen
    s_add_u32 s71, s70, 65536
    buffer_load_dwordx4 v[200:203], v12, s[20:23], s71 offen
    s_add_u32 s71, s70, 98304
    buffer_load_dwordx4 v[204:207], v12, s[20:23], s71 offen
Lnw_46:
    s_and_b32 s65, s3, 3
    v_and_b32 v7, 1, v3
    v_lshlrev_b32 v7, 5, v7
    v_lshrrev_b32 v8, 1, v3
    v_lshl_add_u32 v7, v8, 4, v7
    v_lshl_add_u32 v7, v2, 14, v7
    s_lshl_b32 s64, s52, 5
    s_lshl_b32 s67, s57, 4
    s_add_u32 s64, s64, s67
    s_lshl_b32 s66, s64, 14
    s_lshl_b32 s67, s58, 10
    s_add_u32 s66, s66, s67
    s_lshl_b32 s67, s65, 8
    s_add_u32 s66, s66, s67
    s_add_u32 s66, s66, 2097152
    s_lshl_b32 s64, s64, 10
    s_add_u32 s64, s64, s67
    s_lshl_b32 s67, s58, 4
    s_add_u32 s64, s64, s67
    s_add_u32 s64, s64, 524288
    v_lshlrev_b32 v8, 10, v2
    v_add_u32 v18, 147456, v6
    v_lshlrev_b32 v9, 4, v2
    v_add_u32 v9, 151808, v9
    v_lshlrev_b32 v10, 6, v2
    v_add_u32 v10, 157184, v10
    v_mov_b32 v26, s60
    v_mov_b32 v27, s61
    s_barrier
    ds_read_b128 v[32:35], v18 offset:0
    ds_read_b128 v[36:39], v18 offset:1024
    ds_read_b128 v[40:43], v18 offset:2048
    ds_read_b128 v[44:47], v18 offset:3072
    ds_read_b128 v[12:15], v9
    ds_read_b128 v[208:211], v10 offset:0
    ds_read_b128 v[212:215], v10 offset:16
    ds_read_b128 v[216:219], v10 offset:32
    ds_read_b128 v[220:223], v10 offset:48
    s_waitcnt lgkmcnt(8)
    s_barrier
    s_cmp_eq_u32 s62, 0
    s_cbranch_scc1 L_pvs
    s_waitcnt lgkmcnt(8)
    v_mfma_f32_16x16x32_bf16 v[224:227], v[64:67], v[32:35], 0
    v_mfma_f32_16x16x32_bf16 v[228:231], v[80:83], v[32:35], 0
    s_waitcnt lgkmcnt(7)
    v_mfma_f32_16x16x32_bf16 v[224:227], v[68:71], v[36:39], v[224:227]
    v_mfma_f32_16x16x32_bf16 v[228:231], v[84:87], v[36:39], v[228:231]
    s_waitcnt lgkmcnt(6)
    v_mfma_f32_16x16x32_bf16 v[224:227], v[72:75], v[40:43], v[224:227]
    v_mfma_f32_16x16x32_bf16 v[228:231], v[88:91], v[40:43], v[228:231]
    s_waitcnt lgkmcnt(5)
    v_mfma_f32_16x16x32_bf16 v[224:227], v[76:79], v[44:47], v[224:227]
    v_mfma_f32_16x16x32_bf16 v[228:231], v[92:95], v[44:47], v[228:231]
    v_mfma_f32_16x16x32_bf16 v[232:235], v[96:99], v[32:35], 0
    v_mfma_f32_16x16x32_bf16 v[236:239], v[112:115], v[32:35], 0
    s_waitcnt lgkmcnt(0)
    v_max3_f32 v24, v12, v13, v14
    v_max_f32 v24, v24, v15
    v_mfma_f32_16x16x32_bf16 v[232:235], v[100:103], v[36:39], v[232:235]
    v_mfma_f32_16x16x32_bf16 v[236:239], v[116:119], v[36:39], v[236:239]
    v_cvt_pk_bf16_f32 v48, v224, v225
    v_cvt_pk_bf16_f32 v49, v226, v227
    v_cvt_pk_bf16_f32 v50, v228, v229
    v_cvt_pk_bf16_f32 v51, v230, v231
    v_mfma_f32_16x16x32_bf16 v[232:235], v[104:107], v[40:43], v[232:235]
    v_mfma_f32_16x16x32_bf16 v[236:239], v[120:123], v[40:43], v[236:239]
    v_permlane16_swap_b32 v48, v50
    v_permlane16_swap_b32 v49, v51
    buffer_store_dwordx4 v[48:51], v7, s[48:51], s66 offen offset:0
    v_mfma_f32_16x16x32_bf16 v[232:235], v[108:111], v[44:47], v[232:235]
    v_mfma_f32_16x16x32_bf16 v[236:239], v[124:127], v[44:47], v[236:239]
    v_add_f32 v208, v208, v209
    v_add_f32 v223, v223, v210
    v_add_f32 v208, v208, v211
    v_add_f32 v223, v223, v212
    v_add_f32 v208, v208, v213
    v_add_f32 v223, v223, v214
    v_mfma_f32_16x16x32_bf16 v[240:243], v[128:131], v[32:35], 0
    v_mfma_f32_16x16x32_bf16 v[244:247], v[144:147], v[32:35], 0
    v_mfma_f32_16x16x32_bf16 v[240:243], v[132:135], v[36:39], v[240:243]
    v_mfma_f32_16x16x32_bf16 v[244:247], v[148:151], v[36:39], v[244:247]
    v_cvt_pk_bf16_f32 v52, v232, v233
    v_cvt_pk_bf16_f32 v53, v234, v235
    v_cvt_pk_bf16_f32 v54, v236, v237
    v_cvt_pk_bf16_f32 v55, v238, v239
    v_mfma_f32_16x16x32_bf16 v[240:243], v[136:139], v[40:43], v[240:243]
    v_mfma_f32_16x16x32_bf16 v[244:247], v[152:155], v[40:43], v[244:247]
    v_permlane16_swap_b32 v52, v54
    v_permlane16_swap_b32 v53, v55
    buffer_store_dwordx4 v[52:55], v7, s[48:51], s66 offen offset:64
    v_mfma_f32_16x16x32_bf16 v[240:243], v[140:143], v[44:47], v[240:243]
    v_mfma_f32_16x16x32_bf16 v[244:247], v[156:159], v[44:47], v[244:247]
    v_add_f32 v208, v208, v215
    v_add_f32 v223, v223, v216
    v_add_f32 v208, v208, v217
    v_add_f32 v223, v223, v218
    v_mfma_f32_16x16x32_bf16 v[248:251], v[160:163], v[32:35], 0
    v_mfma_f32_16x16x32_bf16 v[252:255], v[176:179], v[32:35], 0
    v_mfma_f32_16x16x32_bf16 v[248:251], v[164:167], v[36:39], v[248:251]
    v_mfma_f32_16x16x32_bf16 v[252:255], v[180:183], v[36:39], v[252:255]
    v_cvt_pk_bf16_f32 v56, v240, v241
    v_cvt_pk_bf16_f32 v57, v242, v243
    v_cvt_pk_bf16_f32 v58, v244, v245
    v_cvt_pk_bf16_f32 v59, v246, v247
    v_mfma_f32_16x16x32_bf16 v[248:251], v[168:171], v[40:43], v[248:251]
    v_mfma_f32_16x16x32_bf16 v[252:255], v[184:187], v[40:43], v[252:255]
    v_permlane16_swap_b32 v56, v58
    v_permlane16_swap_b32 v57, v59
    buffer_store_dwordx4 v[56:59], v7, s[48:51], s66 offen offset:128
    v_mfma_f32_16x16x32_bf16 v[248:251], v[172:175], v[44:47], v[248:251]
    v_mfma_f32_16x16x32_bf16 v[252:255], v[188:191], v[44:47], v[252:255]
    v_add_f32 v208, v208, v219
    v_add_f32 v223, v223, v220
    v_add_f32 v208, v208, v221
    v_add_f32 v223, v223, v222
    v_add_f32 v25, v208, v223
    s_nop 1
    v_cvt_pk_bf16_f32 v60, v248, v249
    v_cvt_pk_bf16_f32 v61, v250, v251
    v_cvt_pk_bf16_f32 v62, v252, v253
    v_cvt_pk_bf16_f32 v63, v254, v255
    s_nop 0
    v_permlane16_swap_b32 v60, v62
    v_permlane16_swap_b32 v61, v63
    buffer_store_dwordx4 v[60:63], v7, s[48:51], s66 offen offset:192
    s_mov_b32 exec_hi, 0
    s_mov_b32 exec_lo, 0xffff
    s_waitcnt vmcnt(0)
    buffer_store_dwordx4 v[24:27], v8, s[48:51], s64 offen
    s_mov_b64 exec, -1
    s_branch L_pve
L_pvs:
    s_waitcnt lgkmcnt(8)
    v_mfma_f32_16x16x32_bf16 v[224:227], v[64:67], v[32:35], 0
    v_mfma_f32_16x16x32_bf16 v[228:231], v[80:83], v[32:35], 0
    s_waitcnt lgkmcnt(7)
    v_mfma_f32_16x16x32_bf16 v[224:227], v[68:71], v[36:39], v[224:227]
    v_mfma_f32_16x16x32_bf16 v[228:231], v[84:87], v[36:39], v[228:231]
    s_waitcnt lgkmcnt(6)
    v_mfma_f32_16x16x32_bf16 v[224:227], v[72:75], v[40:43], v[224:227]
    v_mfma_f32_16x16x32_bf16 v[228:231], v[88:91], v[40:43], v[228:231]
    s_waitcnt lgkmcnt(5)
    v_mfma_f32_16x16x32_bf16 v[224:227], v[76:79], v[44:47], v[224:227]
    v_mfma_f32_16x16x32_bf16 v[228:231], v[92:95], v[44:47], v[228:231]
    v_mfma_f32_16x16x32_bf16 v[232:235], v[96:99], v[32:35], 0
    v_mfma_f32_16x16x32_bf16 v[236:239], v[112:115], v[32:35], 0
    s_waitcnt lgkmcnt(0)
    v_max3_f32 v24, v12, v13, v14
    v_max_f32 v24, v24, v15
    v_mfma_f32_16x16x32_bf16 v[232:235], v[100:103], v[36:39], v[232:235]
    v_mfma_f32_16x16x32_bf16 v[236:239], v[116:119], v[36:39], v[236:239]
    v_cvt_pk_bf16_f32 v48, v224, v225
    v_cvt_pk_bf16_f32 v49, v226, v227
    v_cvt_pk_bf16_f32 v50, v228, v229
    v_cvt_pk_bf16_f32 v51, v230, v231
    v_mfma_f32_16x16x32_bf16 v[232:235], v[104:107], v[40:43], v[232:235]
    v_mfma_f32_16x16x32_bf16 v[236:239], v[120:123], v[40:43], v[236:239]
    v_permlane16_swap_b32 v48, v50
    v_permlane16_swap_b32 v49, v51
    buffer_store_dwordx4 v[48:51], v7, s[48:51], s66 offen offset:0 sc1
    v_mfma_f32_16x16x32_bf16 v[232:235], v[108:111], v[44:47], v[232:235]
    v_mfma_f32_16x16x32_bf16 v[236:239], v[124:127], v[44:47], v[236:239]
    v_add_f32 v208, v208, v209
    v_add_f32 v223, v223, v210
    v_add_f32 v208, v208, v211
    v_add_f32 v223, v223, v212
    v_add_f32 v208, v208, v213
    v_add_f32 v223, v223, v214
    v_mfma_f32_16x16x32_bf16 v[240:243], v[128:131], v[32:35], 0
    v_mfma_f32_16x16x32_bf16 v[244:247], v[144:147], v[32:35], 0
    v_mfma_f32_16x16x32_bf16 v[240:243], v[132:135], v[36:39], v[240:243]
    v_mfma_f32_16x16x32_bf16 v[244:247], v[148:151], v[36:39], v[244:247]
    v_cvt_pk_bf16_f32 v52, v232, v233
    v_cvt_pk_bf16_f32 v53, v234, v235
    v_cvt_pk_bf16_f32 v54, v236, v237
    v_cvt_pk_bf16_f32 v55, v238, v239
    v_mfma_f32_16x16x32_bf16 v[240:243], v[136:139], v[40:43], v[240:243]
    v_mfma_f32_16x16x32_bf16 v[244:247], v[152:155], v[40:43], v[244:247]
    v_permlane16_swap_b32 v52, v54
    v_permlane16_swap_b32 v53, v55
    buffer_store_dwordx4 v[52:55], v7, s[48:51], s66 offen offset:64 sc1
    v_mfma_f32_16x16x32_bf16 v[240:243], v[140:143], v[44:47], v[240:243]
    v_mfma_f32_16x16x32_bf16 v[244:247], v[156:159], v[44:47], v[244:247]
    v_add_f32 v208, v208, v215
    v_add_f32 v223, v223, v216
    v_add_f32 v208, v208, v217
    v_add_f32 v223, v223, v218
    v_mfma_f32_16x16x32_bf16 v[248:251], v[160:163], v[32:35], 0
    v_mfma_f32_16x16x32_bf16 v[252:255], v[176:179], v[32:35], 0
    v_mfma_f32_16x16x32_bf16 v[248:251], v[164:167], v[36:39], v[248:251]
    v_mfma_f32_16x16x32_bf16 v[252:255], v[180:183], v[36:39], v[252:255]
    v_cvt_pk_bf16_f32 v56, v240, v241
    v_cvt_pk_bf16_f32 v57, v242, v243
    v_cvt_pk_bf16_f32 v58, v244, v245
    v_cvt_pk_bf16_f32 v59, v246, v247
    v_mfma_f32_16x16x32_bf16 v[248:251], v[168:171], v[40:43], v[248:251]
    v_mfma_f32_16x16x32_bf16 v[252:255], v[184:187], v[40:43], v[252:255]
    v_permlane16_swap_b32 v56, v58
    v_permlane16_swap_b32 v57, v59
    buffer_store_dwordx4 v[56:59], v7, s[48:51], s66 offen offset:128 sc1
    v_mfma_f32_16x16x32_bf16 v[248:251], v[172:175], v[44:47], v[248:251]
    v_mfma_f32_16x16x32_bf16 v[252:255], v[188:191], v[44:47], v[252:255]
    v_add_f32 v208, v208, v219
    v_add_f32 v223, v223, v220
    v_add_f32 v208, v208, v221
    v_add_f32 v223, v223, v222
    v_add_f32 v25, v208, v223
    s_nop 1
    v_cvt_pk_bf16_f32 v60, v248, v249
    v_cvt_pk_bf16_f32 v61, v250, v251
    v_cvt_pk_bf16_f32 v62, v252, v253
    v_cvt_pk_bf16_f32 v63, v254, v255
    s_nop 0
    v_permlane16_swap_b32 v60, v62
    v_permlane16_swap_b32 v61, v63
    buffer_store_dwordx4 v[60:63], v7, s[48:51], s66 offen offset:192 sc1
    s_mov_b32 exec_hi, 0
    s_mov_b32 exec_lo, 0xffff
    s_waitcnt vmcnt(0)
    buffer_store_dwordx4 v[24:27], v8, s[48:51], s64 offen sc1
    s_mov_b64 exec, -1
L_pve:
L_post:
    v_and_b32 v14, 1, v2
    v_lshlrev_b32 v14, 4, v14
    v_mov_b32 v15, 0xffff
    v_lshlrev_b32 v14, v14, v15
    v_lshrrev_b32 v15, 1, v2
    v_mov_b32 v16, 0
    v_cmp_eq_u32 vcc, 0, v15
    s_nop 1
    v_cndmask_b32 v10, v16, v14, vcc
    v_cmp_eq_u32 vcc, 1, v15
    s_nop 1
    v_cndmask_b32 v11, v16, v14, vcc
    v_cmp_eq_u32 vcc, 2, v15
    s_nop 1
    v_cndmask_b32 v12, v16, v14, vcc
    v_cmp_eq_u32 vcc, 3, v15
    s_nop 1
    v_cndmask_b32 v13, v16, v14, vcc
    v_lshlrev_b32 v29, 4, v3
    v_mov_b32 v26, s60
    v_mov_b32 v27, s61
    s_cmp_ge_u32 s53, 16
    s_cbranch_scc1 L_wtype
    s_lshl_b32 s65, s3, 12
    s_add_u32 s65, s65, 65536
    v_add_u32 v7, s65, v6
    s_waitcnt vmcnt(1)
    s_cmp_ge_u32 s3, 4
    s_cbranch_scc1 L_rs1
    s_waitcnt vmcnt(0)
L_rs1:
    ds_write_b128 v7, v[192:195] offset:0
    ds_write_b128 v7, v[196:199] offset:1024
    ds_write_b128 v7, v[200:203] offset:2048
    ds_write_b128 v7, v[204:207] offset:3072
    s_lshr_b32 s66, s3, 2
    s_lshl_b32 s66, s66, 4
    s_add_u32 s66, s66, s53
    s_and_b32 s69, s3, 3
    s_lshl_b32 s65, s52, 5
    s_add_u32 s65, s65, s66
    s_lshl_b32 s64, s65, 10
    s_lshl_b32 s67, s69, 8
    s_add_u32 s64, s64, s67
    s_add_u32 s64, s64, 524288
    s_lshl_b32 s100, s65, 14
    s_add_u32 s100, s100, s67
    s_add_u32 s100, s100, 2097152
    v_lshlrev_b32 v17, 10, v3
    v_lshl_add_u32 v17, v2, 4, v17
    v_add_u32 v52, 4096, v17
    v_add_u32 v53, 8192, v17
    v_add_u32 v54, 12288, v17
    s_lshl_b32 s101, s66, 2
    s_add_u32 s101, s101, s69
    s_lshl_b32 s101, s101, 13
    s_lshl_b32 s65, s52, 10
    s_add_u32 s101, s101, s65
    s_add_u32 s101, s101, 6291456
    v_mov_b32 v58, s60
    v_mov_b32 v59, s61
    s_cmp_ge_u32 s3, 4
    s_cbranch_scc1 L_rs2
    s_sleep 18
L_rs2:
    s_mov_b32 s79, 0
    s_mov_b64 exec, -1
    buffer_load_dwordx4 v[32:35], v29, s[48:51], s64 offen offset:0 sc1
    buffer_load_dwordx4 v[36:39], v29, s[48:51], s64 offen offset:64 sc1
    buffer_load_dwordx4 v[40:43], v29, s[48:51], s64 offen offset:128 sc1
    buffer_load_dwordx4 v[44:47], v29, s[48:51], s64 offen offset:192 sc1
    s_branch Lc_a1_49
Lp_a1_47:
    s_mov_b64 exec, s[80:81]
    s_cbranch_execz Ls_50
    buffer_load_dwordx4 v[32:35], v29, s[48:51], s64 offen offset:0 sc1
Ls_50:
    s_mov_b64 exec, s[82:83]
    s_cbranch_execz Ls_51
    buffer_load_dwordx4 v[36:39], v29, s[48:51], s64 offen offset:64 sc1
Ls_51:
    s_mov_b64 exec, s[84:85]
    s_cbranch_execz Ls_52
    buffer_load_dwordx4 v[40:43], v29, s[48:51], s64 offen offset:128 sc1
Ls_52:
    s_mov_b64 exec, s[86:87]
    s_cbranch_execz Ls_53
    buffer_load_dwordx4 v[44:47], v29, s[48:51], s64 offen offset:192 sc1
Ls_53:
    s_mov_b64 exec, -1
Lc_a1_49:
    s_waitcnt vmcnt(0)
    v_cmp_ne_u64 s[80:81], v[34:35], s[60:61]
    v_cmp_ne_u64 s[82:83], v[38:39], s[60:61]
    v_cmp_ne_u64 s[84:85], v[42:43], s[60:61]
    v_cmp_ne_u64 s[86:87], v[46:47], s[60:61]
    s_mov_b64 s[76:77], s[80:81]
    s_or_b64 s[76:77], s[76:77], s[82:83]
    s_or_b64 s[76:77], s[76:77], s[84:85]
    s_or_b64 s[76:77], s[76:77], s[86:87]
    s_add_u32 s79, s79, 1
    s_cmp_gt_u32 s79, 100000
    s_cbranch_scc1 Lq_a1_48
    s_cmp_lg_u64 s[76:77], 0
    s_cbranch_scc1 Lp_a1_47
Lq_a1_48:
    s_mov_b64 exec, -1
    buffer_load_dwordx4 v[80:83], v17, s[48:51], s100 offen sc1
    buffer_load_dwordx4 v[84:87], v52, s[48:51], s100 offen sc1
    buffer_load_dwordx4 v[88:91], v53, s[48:51], s100 offen sc1
    buffer_load_dwordx4 v[92:95], v54, s[48:51], s100 offen sc1
    v_max3_f32 v56, v32, v36, v40
    v_max_f32 v56, v56, v44
    v_mov_b32 v57, v56
    s_nop 1
    v_permlane16_swap_b32 v56, v57
    v_max_f32 v56, v56, v57
    v_mov_b32 v57, v56
    s_nop 1
    v_permlane32_swap_b32 v56, v57
    v_max_f32 v56, v56, v57
    v_sub_f32 v32, v32, v56
    v_sub_f32 v36, v36, v56
    v_sub_f32 v40, v40, v56
    v_sub_f32 v44, v44, v56
    v_exp_f32 v32, v32
    v_exp_f32 v36, v36
    v_exp_f32 v40, v40
    v_exp_f32 v44, v44
    v_cvt_pk_bf16_f32 v34, v32, v32
    v_cvt_pk_bf16_f32 v38, v36, v36
    v_cvt_pk_bf16_f32 v42, v40, v40
    v_cvt_pk_bf16_f32 v46, v44, v44
    v_and_b32 v96, v34, v10
    v_and_b32 v97, v34, v11
    v_and_b32 v98, v34, v12
    v_and_b32 v99, v34, v13
    v_and_b32 v100, v38, v10
    v_and_b32 v101, v38, v11
    v_and_b32 v102, v38, v12
    v_and_b32 v103, v38, v13
    v_and_b32 v104, v42, v10
    v_and_b32 v105, v42, v11
    v_and_b32 v106, v42, v12
    v_and_b32 v107, v42, v13
    v_and_b32 v108, v46, v10
    v_and_b32 v109, v46, v11
    v_and_b32 v110, v46, v12
    v_and_b32 v111, v46, v13
    s_waitcnt vmcnt(3)
    v_mfma_f32_16x16x32_bf16 v[20:23], v[96:99], v[80:83], 0
    s_waitcnt vmcnt(2)
    v_mfma_f32_16x16x32_bf16 v[20:23], v[100:103], v[84:87], v[20:23]
    s_waitcnt vmcnt(1)
    v_mfma_f32_16x16x32_bf16 v[20:23], v[104:107], v[88:91], v[20:23]
    s_waitcnt vmcnt(0)
    v_mfma_f32_16x16x32_bf16 v[20:23], v[108:111], v[92:95], v[20:23]
    v_and_b32 v32, 0xffff0000, v34
    v_and_b32 v36, 0xffff0000, v38
    v_and_b32 v40, 0xffff0000, v42
    v_and_b32 v44, 0xffff0000, v46
    v_mul_f32 v57, v32, v33
    v_fmac_f32 v57, v36, v37
    v_fmac_f32 v57, v40, v41
    v_fmac_f32 v57, v44, v45
    v_cvt_pk_bf16_f32 v24, v20, v21
    v_cvt_pk_bf16_f32 v25, v22, v23
    s_mov_b32 exec_hi, 0
    buffer_store_dwordx4 v[24:27], v6, s[48:51], s101 offen sc1
    s_mov_b64 exec, -1
    v_mov_b32 v18, v57
    s_nop 1
    v_permlane16_swap_b32 v57, v18
    v_add_f32 v57, v57, v18
    v_mov_b32 v18, v57
    s_nop 1
    v_permlane32_swap_b32 v57, v18
    v_add_f32 v57, v57, v18
    s_mov_b64 exec, 1
    buffer_store_dwordx4 v[56:59], v6, s[48:51], s101 offen offset:512 sc1
    s_mov_b64 exec, -1
    s_waitcnt lgkmcnt(0)
    s_barrier
    v_and_b32 v80, 0x3f803f80, v10
    v_and_b32 v81, 0x3f803f80, v11
    v_lshrrev_b32 v7, 2, v1
    v_and_b32 v8, 3, v1
    v_lshlrev_b32 v25, 8, v7
    v_lshl_add_u32 v25, v8, 3, v25
    s_lshl_b32 s65, s3, 5
    s_add_u32 s65, s65, 65536
    v_add_u32 v25, s65, v25
    ds_read_b64_tr_b16 v[64:65], v25 offset:0
    ds_read_b64_tr_b16 v[66:67], v25 offset:4096
    ds_read_b64_tr_b16 v[68:69], v25 offset:8192
    ds_read_b64_tr_b16 v[70:71], v25 offset:12288
    ds_read_b64_tr_b16 v[72:73], v25 offset:16384
    ds_read_b64_tr_b16 v[74:75], v25 offset:20480
    ds_read_b64_tr_b16 v[76:77], v25 offset:24576
    ds_read_b64_tr_b16 v[78:79], v25 offset:28672
    v_and_b32 v24, 7, v2
    s_movk_i32 s64, 264
    v_lshlrev_b32 v7, 3, v3
    v_mad_u32_u24 v7, v24, s64, v7
    v_add_u32 v7, 155904, v7
    v_lshlrev_b32 v8, 3, v24
    v_add_u32 v8, 158016, v8
    s_lshl_b32 s66, s52, 4
    s_add_u32 s66, s66, s53
    s_lshl_b32 s66, s66, 9
    s_lshl_b32 s67, s3, 6
    s_add_u32 s66, s66, s67
    s_add_u32 s66, s66, 1048576
    s_cmp_lg_u32 s3, 0
    s_cbranch_scc1 L_a2w
    v_lshrrev_b32 v53, 5, v1
    v_and_b32 v30, 31, v1
    v_lshlrev_b32 v30, 4, v30
    v_lshl_add_u32 v30, v53, 10, v30
    v_add_u32 v54, 4096, v30
    v_lshlrev_b32 v31, 10, v24
    v_and_b32 v52, 1, v3
    v_lshl_add_u32 v52, v2, 1, v52
    v_lshlrev_b32 v52, 3, v52
    v_mad_u32_u24 v52, v53, s64, v52
    v_add_u32 v52, 155904, v52
    s_lshl_b32 s64, s52, 4
    s_add_u32 s64, s64, s53
    s_lshl_b32 s64, s64, 13
    s_add_u32 s64, s64, 6291456
    s_mov_b32 s79, 0
    s_mov_b64 exec, -1
    buffer_load_dwordx4 v[32:35], v30, s[48:51], s64 offen offset:0 sc1
    buffer_load_dwordx4 v[36:39], v30, s[48:51], s64 offen offset:2048 sc1
    buffer_load_dwordx4 v[40:43], v54, s[48:51], s64 offen offset:0 sc1
    buffer_load_dwordx4 v[44:47], v54, s[48:51], s64 offen offset:2048 sc1
    buffer_load_dwordx4 v[48:51], v31, s[48:51], s64 offen offset:512 sc1
    s_branch Lc_a2_56
Lp_a2_54:
    s_mov_b64 exec, s[80:81]
    s_cbranch_execz Ls_57
    buffer_load_dwordx4 v[32:35], v30, s[48:51], s64 offen offset:0 sc1
Ls_57:
    s_mov_b64 exec, s[82:83]
    s_cbranch_execz Ls_58
    buffer_load_dwordx4 v[36:39], v30, s[48:51], s64 offen offset:2048 sc1
Ls_58:
    s_mov_b64 exec, s[84:85]
    s_cbranch_execz Ls_59
    buffer_load_dwordx4 v[40:43], v54, s[48:51], s64 offen offset:0 sc1
Ls_59:
    s_mov_b64 exec, s[86:87]
    s_cbranch_execz Ls_60
    buffer_load_dwordx4 v[44:47], v54, s[48:51], s64 offen offset:2048 sc1
Ls_60:
    s_mov_b64 exec, s[88:89]
    s_cbranch_execz Ls_61
    buffer_load_dwordx4 v[48:51], v31, s[48:51], s64 offen offset:512 sc1
Ls_61:
    s_mov_b64 exec, -1
Lc_a2_56:
    s_waitcnt vmcnt(0)
    v_cmp_ne_u64 s[80:81], v[34:35], s[60:61]
    v_cmp_ne_u64 s[82:83], v[38:39], s[60:61]
    v_cmp_ne_u64 s[84:85], v[42:43], s[60:61]
    v_cmp_ne_u64 s[86:87], v[46:47], s[60:61]
    v_cmp_ne_u64 s[88:89], v[50:51], s[60:61]
    s_mov_b64 s[76:77], s[80:81]
    s_or_b64 s[76:77], s[76:77], s[82:83]
    s_or_b64 s[76:77], s[76:77], s[84:85]
    s_or_b64 s[76:77], s[76:77], s[86:87]
    s_or_b64 s[76:77], s[76:77], s[88:89]
    s_add_u32 s79, s79, 1
    s_cmp_gt_u32 s79, 100000
    s_cbranch_scc1 Lq_a2_55
    s_cmp_lg_u64 s[76:77], 0
    s_cbranch_scc1 Lp_a2_54
Lq_a2_55:
    s_mov_b64 exec, -1
    ds_write_b64 v52, v[32:33] offset:0
    ds_write_b64 v52, v[36:37] offset:528
    ds_write_b64 v52, v[40:41] offset:1056
    ds_write_b64 v52, v[44:45] offset:1584
    ds_write_b64 v8, v[48:49]
L_a2w:
    s_waitcnt lgkmcnt(0)
    s_barrier
    ds_read_b64 v[48:49], v8
    ds_read_b64 v[32:33], v7 offset:0
    ds_read_b64 v[34:35], v7 offset:32
    ds_read_b64 v[36:37], v7 offset:64
    ds_read_b64 v[38:39], v7 offset:96
    ds_read_b64 v[40:41], v7 offset:128
    ds_read_b64 v[42:43], v7 offset:160
    ds_read_b64 v[44:45], v7 offset:192
    ds_read_b64 v[46:47], v7 offset:224
    s_waitcnt lgkmcnt(8)
    v_mov_b32 v16, v48
    s_nop 1
    v_max_f32_dpp v16, v16, v16 quad_perm:[1,0,3,2] row_mask:0xf bank_mask:0xf
    s_nop 1
    v_max_f32_dpp v16, v16, v16 quad_perm:[2,3,0,1] row_mask:0xf bank_mask:0xf
    s_nop 1
    v_max_f32_dpp v16, v16, v16 row_half_mirror row_mask:0xf bank_mask:0xf
    s_waitcnt lgkmcnt(7)
    v_mfma_f32_16x16x16_bf16 v[20:23], v[64:65], v[32:33], 0
    s_waitcnt lgkmcnt(6)
    v_mfma_f32_16x16x16_bf16 v[20:23], v[66:67], v[34:35], v[20:23]
    v_sub_f32 v16, v48, v16
    v_exp_f32 v16, v16
    s_waitcnt lgkmcnt(5)
    v_mfma_f32_16x16x16_bf16 v[20:23], v[68:69], v[36:37], v[20:23]
    v_mul_f32 v17, v16, v49
    s_waitcnt lgkmcnt(4)
    v_mfma_f32_16x16x16_bf16 v[20:23], v[70:71], v[38:39], v[20:23]
    v_add_f32_dpp v17, v17, v17 quad_perm:[1,0,3,2] row_mask:0xf bank_mask:0xf
    s_waitcnt lgkmcnt(3)
    v_mfma_f32_16x16x16_bf16 v[20:23], v[72:73], v[40:41], v[20:23]
    v_add_f32_dpp v17, v17, v17 quad_perm:[2,3,0,1] row_mask:0xf bank_mask:0xf
    s_waitcnt lgkmcnt(2)
    v_mfma_f32_16x16x16_bf16 v[20:23], v[74:75], v[42:43], v[20:23]
    v_add_f32_dpp v17, v17, v17 row_half_mirror row_mask:0xf bank_mask:0xf
    s_waitcnt lgkmcnt(1)
    v_mfma_f32_16x16x16_bf16 v[20:23], v[76:77], v[44:45], v[20:23]
    v_rcp_f32 v17, v17
    s_waitcnt lgkmcnt(0)
    v_mfma_f32_16x16x16_bf16 v[20:23], v[78:79], v[46:47], v[20:23]
    v_mul_f32 v16, v16, v17
    s_nop 6
    v_mul_f32 v20, v20, v16
    v_mul_f32 v21, v21, v16
    v_mul_f32 v22, v22, v16
    v_mul_f32 v23, v23, v16
    v_add_f32_dpp v20, v20, v20 quad_perm:[1,0,3,2] row_mask:0xf bank_mask:0xf
    v_add_f32_dpp v21, v21, v21 quad_perm:[1,0,3,2] row_mask:0xf bank_mask:0xf
    v_add_f32_dpp v22, v22, v22 quad_perm:[1,0,3,2] row_mask:0xf bank_mask:0xf
    v_add_f32_dpp v23, v23, v23 quad_perm:[1,0,3,2] row_mask:0xf bank_mask:0xf
    v_add_f32_dpp v20, v20, v20 quad_perm:[2,3,0,1] row_mask:0xf bank_mask:0xf
    v_add_f32_dpp v21, v21, v21 quad_perm:[2,3,0,1] row_mask:0xf bank_mask:0xf
    v_add_f32_dpp v22, v22, v22 quad_perm:[2,3,0,1] row_mask:0xf bank_mask:0xf
    v_add_f32_dpp v23, v23, v23 quad_perm:[2,3,0,1] row_mask:0xf bank_mask:0xf
    v_add_f32_dpp v20, v20, v20 row_half_mirror row_mask:0xf bank_mask:0xf
    v_add_f32_dpp v21, v21, v21 row_half_mirror row_mask:0xf bank_mask:0xf
    v_add_f32_dpp v22, v22, v22 row_half_mirror row_mask:0xf bank_mask:0xf
    v_add_f32_dpp v23, v23, v23 row_half_mirror row_mask:0xf bank_mask:0xf
    v_cvt_pk_bf16_f32 v24, v20, v21
    v_cvt_pk_bf16_f32 v25, v22, v23
    s_mov_b64 exec, s[92:93]
    s_cmp_eq_u32 s62, 0
    s_cbranch_scc1 Lf_62
    buffer_store_dwordx4 v[24:27], v29, s[48:51], s66 offen
    s_branch Lg_63
Lf_62:
    buffer_store_dwordx4 v[24:27], v29, s[48:51], s66 offen sc1
Lg_63:
    s_mov_b64 exec, -1
    s_branch L_final
L_wtype:
    v_and_b32 v80, 0x3f803f80, v10
    v_and_b32 v81, 0x3f803f80, v11
    v_lshrrev_b32 v24, 3, v1
    v_and_b32 v28, 7, v1
    v_lshlrev_b32 v28, 4, v28
    v_lshl_add_u32 v119, v24, 10, v28
    s_lshl_b32 s65, s52, 19
    s_bfe_u32 s66, s53, 0x10003
    s_lshl_b32 s66, s66, 18
    s_add_u32 s65, s65, s66
    s_lshl_b32 s66, s3, 15
    s_add_u32 s65, s65, s66
    s_and_b32 s66, s53, 7
    s_lshl_b32 s66, s66, 7
    s_add_u32 s65, s65, s66
    s_lshl_b32 s67, s3, 12
    s_add_u32 s68, s67, 16384
    s_barrier
    s_add_u32 s69, s68, 0
    s_mov_b32 m0, s69
    s_add_u32 s66, s65, 0
    buffer_load_dwordx4 v119, s[24:27], s66 offen lds
    s_add_u32 s69, s68, 1024
    s_mov_b32 m0, s69
    s_add_u32 s66, s65, 8192
    buffer_load_dwordx4 v119, s[24:27], s66 offen lds
    s_add_u32 s69, s68, 2048
    s_mov_b32 m0, s69
    s_add_u32 s66, s65, 16384
    buffer_load_dwordx4 v119, s[24:27], s66 offen lds
    s_add_u32 s69, s68, 3072
    s_mov_b32 m0, s69
    s_add_u32 s66, s65, 24576
    buffer_load_dwordx4 v119, s[24:27], s66 offen lds
    v_lshlrev_b32 v31, 3, v2
    s_lshl_b32 s65, s3, 7
    buffer_load_dwordx2 v[222:223], v31, s[4:7], s65 offen
    s_cmp_ge_u32 s63, 112
    s_cbranch_scc1 L_now12
    s_lshl_b32 s65, s63, 14
    s_lshl_b32 s66, s3, 7
    s_add_u32 s65, s65, s66
    s_lshl_b32 s67, s3, 11
    s_add_u32 s68, s67, 0
    s_mov_b32 m0, s68
    s_add_u32 s66, s65, 8192
    buffer_load_dwordx4 v119, s[36:39], s65 offen lds
    s_add_u32 s68, s68, 1024
    s_mov_b32 m0, s68
    v_lshlrev_b32 v28, 3, v3
    s_lshl_b32 s65, s63, 5
    buffer_load_dwordx4 v119, s[36:39], s66 offen lds
    buffer_load_dwordx2 v[112:113], v28, s[32:35], s65 offen
    v_lshrrev_b32 v24, 1, v1
    v_and_b32 v25, 1, v1
    v_lshlrev_b32 v25, 4, v25
    s_movk_i32 s64, 3584
    v_mad_u32_u24 v24, v24, s64, v25
    s_and_b32 s69, s53, 3
    s_lshl_b32 s69, s69, 1
    s_add_u32 s69, s69, s3
    s_and_b32 s69, s69, 7
    s_mul_i32 s65, s69, 229376
    s_lshl_b32 s66, s63, 5
    s_add_u32 s65, s65, s66
    s_lshl_b32 s68, s69, 11
    s_add_u32 s68, s68, 49152
    s_mov_b32 m0, s68
    s_add_u32 s66, s65, 114688
    buffer_load_dwordx4 v24, s[28:31], s65 offen lds
    s_add_u32 s68, s68, 1024
    s_mov_b32 m0, s68
    s_nop 0
    buffer_load_dwordx4 v24, s[28:31], s66 offen lds
L_now12:
    v_lshrrev_b32 v218, 2, v1
    v_and_b32 v17, 3, v1
    v_lshlrev_b32 v218, 7, v218
    v_lshl_add_u32 v218, v17, 3, v218
    s_lshl_b32 s67, s3, 12
    v_add_u32 v30, s67, v218
    v_bfe_u32 v16, v1, 3, 2
    v_and_b32 v31, 7, v1
    v_lshlrev_b32 v216, 9, v16
    v_lshl_add_u32 v216, v31, 4, v216
    s_lshl_b32 s65, s3, 6
    s_add_u32 s65, s65, 158208
    v_lshlrev_b32 v220, 3, v31
    v_add_u32 v220, s65, v220
    v_lshlrev_b32 v221, 3, v3
    v_add_u32 v221, s65, v221
    s_lshl_b32 s100, s52, 2
    s_bfe_u32 s65, s53, 0x10003
    s_lshl_b32 s65, s65, 1
    s_add_u32 s100, s100, s65
    s_lshr_b32 s65, s3, 2
    s_add_u32 s100, s100, s65
    s_lshl_b32 s100, s100, 11
    s_and_b32 s65, s3, 3
    s_lshl_b32 s65, s65, 7
    s_add_u32 s100, s100, s65
    s_add_u32 s100, s100, 1048576
    s_lshl_b32 s65, s3, 8
    s_add_u32 s65, s65, 152576
    v_lshl_add_u32 v217, v17, 6, v29
    v_add_u32 v217, s65, v217
    v_add_u32 v219, 152576, v6
    v_mov_b32 v18, 0
    v_mov_b32 v19, -1
    v_and_b32 v16, 7, v2
    v_cmp_eq_u32 vcc, 0, v17
    s_nop 1
    v_cndmask_b32 v104, v18, v19, vcc
    v_cmp_eq_u32 vcc, 1, v17
    s_nop 1
    v_cndmask_b32 v105, v18, v19, vcc
    v_cmp_eq_u32 vcc, 2, v17
    s_nop 1
    v_cndmask_b32 v106, v18, v19, vcc
    v_cmp_eq_u32 vcc, 3, v17
    s_nop 1
    v_cndmask_b32 v107, v18, v19, vcc
    v_cmp_eq_u32 vcc, 0, v16
    s_nop 1
    v_cndmask_b32 v208, v18, v19, vcc
    v_cmp_eq_u32 vcc, 1, v16
    s_nop 1
    v_cndmask_b32 v209, v18, v19, vcc
    v_cmp_eq_u32 vcc, 2, v16
    s_nop 1
    v_cndmask_b32 v210, v18, v19, vcc
    v_cmp_eq_u32 vcc, 3, v16
    s_nop 1
    v_cndmask_b32 v211, v18, v19, vcc
    v_cmp_eq_u32 vcc, 4, v16
    s_nop 1
    v_cndmask_b32 v212, v18, v19, vcc
    v_cmp_eq_u32 vcc, 5, v16
    s_nop 1
    v_cndmask_b32 v213, v18, v19, vcc
    v_cmp_eq_u32 vcc, 6, v16
    s_nop 1
    v_cndmask_b32 v214, v18, v19, vcc
    v_cmp_eq_u32 vcc, 7, v16
    s_nop 1
    v_cndmask_b32 v215, v18, v19, vcc
    v_lshlrev_b32 v8, 8, v3
    v_bfe_u32 v9, v1, 2, 2
    v_lshl_add_u32 v8, v9, 5, v8
    v_lshl_add_u32 v8, v17, 3, v8
    v_mov_b32 v32, 0x3f803f80
    v_mov_b32 v33, 0x3f803f80
    v_mov_b32 v34, 0x3f803f80
    v_mov_b32 v35, 0x3f803f80
    s_waitcnt vmcnt(0)
    ds_read_b64_tr_b16 v[64:65], v30 offset:16384
    ds_read_b64_tr_b16 v[66:67], v30 offset:18432
    ds_read_b64_tr_b16 v[68:69], v30 offset:16416
    ds_read_b64_tr_b16 v[70:71], v30 offset:18464
    ds_read_b64_tr_b16 v[72:73], v30 offset:16448
    ds_read_b64_tr_b16 v[74:75], v30 offset:18496
    ds_read_b64_tr_b16 v[76:77], v30 offset:16480
    ds_read_b64_tr_b16 v[78:79], v30 offset:18528
    v_mov_b32 v44, 0
    v_mov_b32 v45, 0
    s_mov_b32 s72, -1
    s_mov_b32 s73, 0
    s_mov_b32 s74, 0x000f000f
    s_mov_b32 s75, 0x000f000f
    s_waitcnt lgkmcnt(0)
    s_mov_b32 s79, 0
    s_mov_b64 exec, s[72:73]
    buffer_load_dwordx4 v[44:47], v216, s[48:51], s100 offen sc1
    s_branch Lc_b_66
Lp_b_64:
    s_mov_b64 exec, s[80:81]
    s_cbranch_execz Ls_67
    buffer_load_dwordx4 v[44:47], v216, s[48:51], s100 offen sc1
Ls_67:
    s_mov_b64 exec, s[72:73]
Lc_b_66:
    s_waitcnt vmcnt(0)
    v_cmp_ne_u64 s[80:81], v[46:47], s[60:61]
    s_mov_b64 s[76:77], s[80:81]
    s_add_u32 s79, s79, 1
    s_cmp_gt_u32 s79, 100000
    s_cbranch_scc1 Lq_b_65
    s_cmp_lg_u64 s[76:77], 0
    s_cbranch_scc1 Lp_b_64
Lq_b_65:
    s_mov_b64 exec, -1
    v_mfma_f32_16x16x16_bf16 v[20:23], v[80:81], v[44:45], 0
    s_nop 7
    v_add_f32_dpp v20, v20, v20 row_ror:8 row_mask:0xf bank_mask:0xf
    v_add_f32_dpp v21, v21, v21 row_ror:8 row_mask:0xf bank_mask:0xf
    v_add_f32_dpp v22, v22, v22 row_ror:8 row_mask:0xf bank_mask:0xf
    v_add_f32_dpp v23, v23, v23 row_ror:8 row_mask:0xf bank_mask:0xf
    v_cvt_pk_bf16_f32 v32, v20, v21
    v_cvt_pk_bf16_f32 v33, v22, v23
    s_mov_b64 exec, 0xff
    ds_write_b64 v220, v[32:33]
    s_mov_b64 exec, -1
    s_waitcnt lgkmcnt(0)
    ds_read_b64 v[32:33], v221
    ds_read_b64 v[34:35], v221 offset:32
    s_waitcnt lgkmcnt(0)
    v_and_b32 v228, v32, v104
    v_and_b32 v229, v33, v104
    v_and_b32 v230, v34, v104
    v_and_b32 v231, v35, v104
    v_and_b32 v232, v32, v105
    v_and_b32 v233, v33, v105
    v_and_b32 v234, v34, v105
    v_and_b32 v235, v35, v105
    v_and_b32 v236, v32, v106
    v_and_b32 v237, v33, v106
    v_and_b32 v238, v34, v106
    v_and_b32 v239, v35, v106
    v_and_b32 v240, v32, v107
    v_and_b32 v241, v33, v107
    v_and_b32 v242, v34, v107
    v_and_b32 v243, v35, v107
    v_mfma_f32_16x16x16_bf16 v[20:23], v[64:65], v[228:229], 0
    v_mfma_f32_16x16x16_bf16 v[20:23], v[66:67], v[230:231], v[20:23]
    v_mfma_f32_16x16x16_bf16 v[20:23], v[68:69], v[232:233], v[20:23]
    v_mfma_f32_16x16x16_bf16 v[20:23], v[70:71], v[234:235], v[20:23]
    v_mfma_f32_16x16x16_bf16 v[20:23], v[72:73], v[236:237], v[20:23]
    v_mfma_f32_16x16x16_bf16 v[20:23], v[74:75], v[238:239], v[20:23]
    v_mfma_f32_16x16x16_bf16 v[20:23], v[76:77], v[240:241], v[20:23]
    v_mfma_f32_16x16x16_bf16 v[20:23], v[78:79], v[242:243], v[20:23]
    s_mov_b64 exec, s[74:75]
    s_nop 6
    ds_write_b128 v217, v[20:23]
    s_mov_b64 exec, -1
    s_waitcnt lgkmcnt(0)
    s_barrier
    s_cmp_lg_u32 s3, 7
    s_cbranch_scc1 L_ffn
    ds_read_b128 v[20:23], v219
    ds_read_b128 v[40:43], v219 offset:1024
    s_lshl_b32 s64, s52, 1
    s_bfe_u32 s65, s53, 0x10003
    s_add_u32 s64, s64, s65
    s_lshl_b32 s64, s64, 11
    s_and_b32 s65, s53, 7
    s_lshl_b32 s65, s65, 8
    s_add_u32 s64, s64, s65
    s_add_u32 s64, s64, 1179648
    s_waitcnt lgkmcnt(0)
    v_add_f32 v20, v20, v40
    v_add_f32 v21, v21, v41
    v_add_f32 v22, v22, v42
    v_add_f32 v23, v23, v43
    v_mov_b32 v16, v20
    v_mov_b32 v17, v21
    v_mov_b32 v18, v22
    v_mov_b32 v19, v23
    v_permlane16_swap_b32 v20, v16
    v_permlane16_swap_b32 v21, v17
    v_permlane16_swap_b32 v22, v18
    v_permlane16_swap_b32 v23, v19
    v_add_f32 v20, v20, v16
    v_add_f32 v21, v21, v17
    v_add_f32 v22, v22, v18
    v_add_f32 v23, v23, v19
    v_mov_b32 v16, v20
    v_mov_b32 v17, v21
    v_mov_b32 v18, v22
    v_mov_b32 v19, v23
    v_permlane32_swap_b32 v20, v16
    v_permlane32_swap_b32 v21, v17
    v_permlane32_swap_b32 v22, v18
    v_permlane32_swap_b32 v23, v19
    v_add_f32 v20, v20, v16
    v_add_f32 v21, v21, v17
    v_add_f32 v22, v22, v18
    v_add_f32 v23, v23, v19
    v_cvt_pk_bf16_f32 v24, v20, v21
    v_cvt_pk_bf16_f32 v25, v22, v23
    s_mov_b32 exec_hi, 0
    s_mov_b32 exec_lo, 0xffff
    buffer_store_dwordx4 v[24:27], v6, s[48:51], s64 offen sc1
    s_mov_b64 exec, -1
L_ffn:
    s_cmp_ge_u32 s63, 112
    s_cbranch_scc1 L_fin
    v_lshlrev_b32 v7, 11, v3
    v_lshl_add_u32 v7, v2, 4, v7
    v_add_u32 v114, 8192, v7
    v_add_u32 v115, 16384, v7
    v_add_u32 v116, 24576, v7
    s_lshl_b32 s64, s3, 8
    s_add_u32 s64, s64, 1179648
    s_lshl_b32 s65, s3, 7
    s_add_u32 s65, s65, 157184
    v_lshlrev_b32 v117, 3, v2
    v_add_u32 v117, s65, v117
    v_add_u32 v118, 157184, v29
    s_lshl_b32 s65, s3, 3
    s_add_u32 s65, s65, 155648
    v_mov_b32 v16, s65
    v_and_b32 v17, 7, v2
    v_lshlrev_b32 v18, 3, v17
    v_add_u32 v18, 155648, v18
    v_lshlrev_b32 v31, 7, v3
    v_lshl_add_u32 v31, v17, 4, v31
    s_lshl_b32 s66, s63, 11
    s_lshl_b32 s65, s3, 9
    s_add_u32 s66, s66, s65
    s_add_u32 s66, s66, 1310720
    s_mov_b32 s100, 0xc0135761
    s_mov_b32 s101, 0xbdd2d3e8
    s_mov_b32 s74, 0x00ff00ff
    s_mov_b32 s75, 0x00ff00ff
    v_lshlrev_b32 v20, 16, v222
    v_and_b32 v21, 0xffff0000, v222
    v_lshlrev_b32 v22, 16, v223
    v_and_b32 v23, 0xffff0000, v223
    s_cmp_ge_u32 s3, 4
    s_cbranch_scc1 L_nofp
    ds_read_b64_tr_b16 v[128:129], v8 offset:49152
    ds_read_b64_tr_b16 v[130:131], v8 offset:49280
    ds_read_b64_tr_b16 v[132:133], v8 offset:50176
    ds_read_b64_tr_b16 v[134:135], v8 offset:50304
    ds_read_b64_tr_b16 v[136:137], v8 offset:51200
    ds_read_b64_tr_b16 v[138:139], v8 offset:51328
    ds_read_b64_tr_b16 v[140:141], v8 offset:52224
    ds_read_b64_tr_b16 v[142:143], v8 offset:52352
    ds_read_b64_tr_b16 v[144:145], v8 offset:53248
    ds_read_b64_tr_b16 v[146:147], v8 offset:53376
    ds_read_b64_tr_b16 v[148:149], v8 offset:54272
    ds_read_b64_tr_b16 v[150:151], v8 offset:54400
    ds_read_b64_tr_b16 v[152:153], v8 offset:55296
    ds_read_b64_tr_b16 v[154:155], v8 offset:55424
    ds_read_b64_tr_b16 v[156:157], v8 offset:56320
    ds_read_b64_tr_b16 v[158:159], v8 offset:56448
    ds_read_b64_tr_b16 v[160:161], v8 offset:57344
    ds_read_b64_tr_b16 v[162:163], v8 offset:57472
    ds_read_b64_tr_b16 v[164:165], v8 offset:58368
    ds_read_b64_tr_b16 v[166:167], v8 offset:58496
    ds_read_b64_tr_b16 v[168:169], v8 offset:59392
    ds_read_b64_tr_b16 v[170:171], v8 offset:59520
    ds_read_b64_tr_b16 v[172:173], v8 offset:60416
    ds_read_b64_tr_b16 v[174:175], v8 offset:60544
    ds_read_b64_tr_b16 v[176:177], v8 offset:61440
    ds_read_b64_tr_b16 v[178:179], v8 offset:61568
    ds_read_b64_tr_b16 v[180:181], v8 offset:62464
    ds_read_b64_tr_b16 v[182:183], v8 offset:62592
    ds_read_b64_tr_b16 v[184:185], v8 offset:63488
    ds_read_b64_tr_b16 v[186:187], v8 offset:63616
    ds_read_b64_tr_b16 v[188:189], v8 offset:64512
    ds_read_b64_tr_b16 v[190:191], v8 offset:64640
    ds_read_b64_tr_b16 v[192:193], v30 offset:0
    ds_read_b64_tr_b16 v[194:195], v30 offset:32
    ds_read_b64_tr_b16 v[196:197], v30 offset:64
    ds_read_b64_tr_b16 v[198:199], v30 offset:96
    ds_read_b64_tr_b16 v[200:201], v30 offset:2048
    ds_read_b64_tr_b16 v[202:203], v30 offset:2080
    ds_read_b64_tr_b16 v[204:205], v30 offset:2112
    ds_read_b64_tr_b16 v[206:207], v30 offset:2144
    v_mov_b32 v32, 0x3f803f80
    v_mov_b32 v33, 0x3f803f80
    v_mov_b32 v34, 0x3f803f80
    v_mov_b32 v35, 0x3f803f80
    v_lshlrev_b32 v88, 16, v112
    v_and_b32 v89, 0xffff0000, v112
    v_lshlrev_b32 v90, 16, v113
    v_and_b32 v91, 0xffff0000, v113
    s_waitcnt lgkmcnt(0)
    v_mfma_f32_16x16x32_bf16 v[84:87], v[128:131], v[32:35], 0
    v_mfma_f32_16x16x32_bf16 v[84:87], v[132:135], v[32:35], v[84:87]
    v_mfma_f32_16x16x32_bf16 v[84:87], v[136:139], v[32:35], v[84:87]
    v_mfma_f32_16x16x32_bf16 v[84:87], v[140:143], v[32:35], v[84:87]
    v_mfma_f32_16x16x32_bf16 v[84:87], v[144:147], v[32:35], v[84:87]
    v_mfma_f32_16x16x32_bf16 v[84:87], v[148:151], v[32:35], v[84:87]
    v_mfma_f32_16x16x32_bf16 v[84:87], v[152:155], v[32:35], v[84:87]
    v_mfma_f32_16x16x32_bf16 v[84:87], v[156:159], v[32:35], v[84:87]
    v_mfma_f32_16x16x32_bf16 v[84:87], v[160:163], v[32:35], v[84:87]
    v_mfma_f32_16x16x32_bf16 v[84:87], v[164:167], v[32:35], v[84:87]
    v_mfma_f32_16x16x32_bf16 v[84:87], v[168:171], v[32:35], v[84:87]
    v_mfma_f32_16x16x32_bf16 v[84:87], v[172:175], v[32:35], v[84:87]
    v_mfma_f32_16x16x32_bf16 v[84:87], v[176:179], v[32:35], v[84:87]
    v_mfma_f32_16x16x32_bf16 v[84:87], v[180:183], v[32:35], v[84:87]
    v_mfma_f32_16x16x32_bf16 v[84:87], v[184:187], v[32:35], v[84:87]
    v_mfma_f32_16x16x32_bf16 v[84:87], v[188:191], v[32:35], v[84:87]
L_nofp:
    s_mov_b32 s79, 0
    s_mov_b64 exec, -1
    buffer_load_dwordx4 v[120:123], v7, s[48:51], s64 offen sc1
    buffer_load_dwordx4 v[124:127], v114, s[48:51], s64 offen sc1
    buffer_load_dwordx4 v[100:103], v115, s[48:51], s64 offen sc1
    buffer_load_dwordx4 v[104:107], v116, s[48:51], s64 offen sc1
    s_branch Lc_c_70
Lp_c_68:
    s_mov_b64 exec, s[80:81]
    s_cbranch_execz Ls_71
    buffer_load_dwordx4 v[120:123], v7, s[48:51], s64 offen sc1
Ls_71:
    s_mov_b64 exec, s[82:83]
    s_cbranch_execz Ls_72
    buffer_load_dwordx4 v[124:127], v114, s[48:51], s64 offen sc1
Ls_72:
    s_mov_b64 exec, s[84:85]
    s_cbranch_execz Ls_73
    buffer_load_dwordx4 v[100:103], v115, s[48:51], s64 offen sc1
Ls_73:
    s_mov_b64 exec, s[86:87]
    s_cbranch_execz Ls_74
    buffer_load_dwordx4 v[104:107], v116, s[48:51], s64 offen sc1
Ls_74:
    s_mov_b64 exec, -1
Lc_c_70:
    s_waitcnt vmcnt(0)
    v_cmp_ne_u64 s[80:81], v[122:123], s[60:61]
    v_cmp_ne_u64 s[82:83], v[126:127], s[60:61]
    v_cmp_ne_u64 s[84:85], v[102:103], s[60:61]
    v_cmp_ne_u64 s[86:87], v[106:107], s[60:61]
    s_mov_b64 s[76:77], s[80:81]
    s_or_b64 s[76:77], s[76:77], s[82:83]
    s_or_b64 s[76:77], s[76:77], s[84:85]
    s_or_b64 s[76:77], s[76:77], s[86:87]
    s_add_u32 s79, s79, 1
    s_cmp_gt_u32 s79, 100000
    s_cbranch_scc1 Lq_c_69
    s_cmp_lg_u64 s[76:77], 0
    s_cbranch_scc1 Lp_c_68
Lq_c_69:
    s_mov_b64 exec, -1
    v_mfma_f32_16x16x16_bf16 v[20:23], v[80:81], v[120:121], v[20:23]
    v_mfma_f32_16x16x16_bf16 v[20:23], v[80:81], v[124:125], v[20:23]
    v_mfma_f32_16x16x16_bf16 v[20:23], v[80:81], v[100:101], v[20:23]
    v_mfma_f32_16x16x16_bf16 v[20:23], v[80:81], v[104:105], v[20:23]
    s_nop 7
    v_cvt_pk_bf16_f32 v24, v20, v21
    v_cvt_pk_bf16_f32 v25, v22, v23
    v_lshlrev_b32 v20, 16, v24
    v_and_b32 v21, 0xffff0000, v24
    v_lshlrev_b32 v22, 16, v25
    v_and_b32 v23, 0xffff0000, v25
    v_add_f32 v96, v20, v21
    v_mul_f32 v97, v20, v20
    v_add_f32 v96, v96, v22
    v_fmac_f32 v97, v21, v21
    v_add_f32 v96, v96, v23
    v_fmac_f32 v97, v22, v22
    s_mov_b32 exec_hi, 0
    s_mov_b32 exec_lo, 0xffff
    ds_write_b64 v117, v[24:25]
    v_fmac_f32 v97, v23, v23
    v_add_f32_dpp v96, v96, v96 quad_perm:[1,0,3,2] row_mask:0xf bank_mask:0xf
    s_nop 0
    v_add_f32_dpp v97, v97, v97 quad_perm:[1,0,3,2] row_mask:0xf bank_mask:0xf
    v_add_f32_dpp v96, v96, v96 quad_perm:[2,3,0,1] row_mask:0xf bank_mask:0xf
    s_nop 0
    v_add_f32_dpp v97, v97, v97 quad_perm:[2,3,0,1] row_mask:0xf bank_mask:0xf
    v_add_f32_dpp v96, v96, v96 row_half_mirror row_mask:0xf bank_mask:0xf
    s_nop 0
    v_add_f32_dpp v97, v97, v97 row_half_mirror row_mask:0xf bank_mask:0xf
    v_add_f32_dpp v96, v96, v96 row_mirror row_mask:0xf bank_mask:0xf
    s_nop 0
    v_add_f32_dpp v97, v97, v97 row_mirror row_mask:0xf bank_mask:0xf
    ds_write_b64 v16, v[96:97]
    s_mov_b64 exec, -1
    s_waitcnt lgkmcnt(0)
    s_barrier
    s_cmp_ge_u32 s3, 4
    s_cbranch_scc1 L_fin
    ds_read_b64 v[96:97], v18
    ds_read_b128 v[32:35], v118 offset:0
    ds_read_b128 v[36:39], v118 offset:64
    ds_read_b128 v[40:43], v118 offset:128
    ds_read_b128 v[44:47], v118 offset:192
    ds_read_b128 v[48:51], v118 offset:256
    ds_read_b128 v[52:55], v118 offset:320
    ds_read_b128 v[56:59], v118 offset:384
    ds_read_b128 v[60:63], v118 offset:448
    s_waitcnt lgkmcnt(7)
    v_mfma_f32_16x16x32_bf16 v[20:23], v[128:131], v[32:35], 0
    ds_read_b128 v[32:35], v118 offset:512
    s_waitcnt lgkmcnt(7)
    v_mfma_f32_16x16x32_bf16 v[20:23], v[132:135], v[36:39], v[20:23]
    ds_read_b128 v[36:39], v118 offset:576
    v_add_f32_dpp v96, v96, v96 quad_perm:[1,0,3,2] row_mask:0xf bank_mask:0xf
    v_add_f32_dpp v97, v97, v97 quad_perm:[1,0,3,2] row_mask:0xf bank_mask:0xf
    s_waitcnt lgkmcnt(7)
    v_mfma_f32_16x16x32_bf16 v[20:23], v[136:139], v[40:43], v[20:23]
    ds_read_b128 v[40:43], v118 offset:640
    v_add_f32_dpp v96, v96, v96 quad_perm:[2,3,0,1] row_mask:0xf bank_mask:0xf
    v_add_f32_dpp v97, v97, v97 quad_perm:[2,3,0,1] row_mask:0xf bank_mask:0xf
    s_waitcnt lgkmcnt(7)
    v_mfma_f32_16x16x32_bf16 v[20:23], v[140:143], v[44:47], v[20:23]
    ds_read_b128 v[44:47], v118 offset:704
    v_add_f32_dpp v96, v96, v96 row_half_mirror row_mask:0xf bank_mask:0xf
    v_add_f32_dpp v97, v97, v97 row_half_mirror row_mask:0xf bank_mask:0xf
    s_waitcnt lgkmcnt(7)
    v_mfma_f32_16x16x32_bf16 v[20:23], v[144:147], v[48:51], v[20:23]
    ds_read_b128 v[48:51], v118 offset:768
    v_mul_f32 v96, 0x3b000000, v96
    v_mul_f32 v98, v96, v96
    v_mov_b32 v99, 0x3727c5ac
    s_waitcnt lgkmcnt(7)
    v_mfma_f32_16x16x32_bf16 v[20:23], v[148:151], v[52:55], v[20:23]
    ds_read_b128 v[52:55], v118 offset:832
    v_sub_f32 v99, v99, v98
    v_fmac_f32 v99, 0x3b000000, v97
    v_rsq_f32 v99, v99
    s_waitcnt lgkmcnt(7)
    v_mfma_f32_16x16x32_bf16 v[20:23], v[152:155], v[56:59], v[20:23]
    ds_read_b128 v[56:59], v118 offset:896
    v_mul_f32 v98, v96, v99
    s_waitcnt lgkmcnt(7)
    v_mfma_f32_16x16x32_bf16 v[20:23], v[156:159], v[60:63], v[20:23]
    ds_read_b128 v[60:63], v118 offset:960
    v_fma_f32 v88, -v98, v84, v88
    v_fma_f32 v89, -v98, v85, v89
    s_waitcnt lgkmcnt(7)
    v_mfma_f32_16x16x32_bf16 v[20:23], v[160:163], v[32:35], v[20:23]
    v_fma_f32 v90, -v98, v86, v90
    v_fma_f32 v91, -v98, v87, v91
    s_waitcnt lgkmcnt(6)
    v_mfma_f32_16x16x32_bf16 v[20:23], v[164:167], v[36:39], v[20:23]
    s_waitcnt lgkmcnt(5)
    v_mfma_f32_16x16x32_bf16 v[20:23], v[168:171], v[40:43], v[20:23]
    s_waitcnt lgkmcnt(4)
    v_mfma_f32_16x16x32_bf16 v[20:23], v[172:175], v[44:47], v[20:23]
    s_waitcnt lgkmcnt(3)
    v_mfma_f32_16x16x32_bf16 v[20:23], v[176:179], v[48:51], v[20:23]
    s_waitcnt lgkmcnt(2)
    v_mfma_f32_16x16x32_bf16 v[20:23], v[180:183], v[52:55], v[20:23]
    s_waitcnt lgkmcnt(1)
    v_mfma_f32_16x16x32_bf16 v[20:23], v[184:187], v[56:59], v[20:23]
    s_waitcnt lgkmcnt(0)
    v_mfma_f32_16x16x32_bf16 v[20:23], v[188:191], v[60:63], v[20:23]
    s_nop 7
    v_fma_f32 v20, v20, v99, v88
    v_fma_f32 v21, v21, v99, v89
    v_fma_f32 v22, v22, v99, v90
    v_fma_f32 v23, v23, v99, v91
    v_mul_f32 v100, v20, v20
    v_mul_f32 v101, v21, v21
    v_mul_f32 v102, v22, v22
    v_mul_f32 v103, v23, v23
    v_mov_b32 v104, s100
    v_fmac_f32 v104, s101, v100
    v_mov_b32 v105, s100
    v_fmac_f32 v105, s101, v101
    v_mov_b32 v106, s100
    v_fmac_f32 v106, s101, v102
    v_mov_b32 v107, s100
    v_fmac_f32 v107, s101, v103
    v_mul_f32 v104, v104, v20
    v_mul_f32 v105, v105, v21
    v_mul_f32 v106, v106, v22
    v_mul_f32 v107, v107, v23
    v_exp_f32 v104, v104
    v_exp_f32 v105, v105
    v_exp_f32 v106, v106
    v_exp_f32 v107, v107
    v_add_f32 v104, 1.0, v104
    v_add_f32 v105, 1.0, v105
    v_add_f32 v106, 1.0, v106
    v_add_f32 v107, 1.0, v107
    v_rcp_f32 v104, v104
    v_rcp_f32 v105, v105
    v_rcp_f32 v106, v106
    v_rcp_f32 v107, v107
    v_mul_f32 v20, v20, v104
    v_mul_f32 v21, v21, v105
    v_mul_f32 v22, v22, v106
    v_mul_f32 v23, v23, v107
    v_cvt_pk_bf16_f32 v16, v20, v21
    v_cvt_pk_bf16_f32 v17, v22, v23
    v_and_b32 v32, v16, v208
    v_and_b32 v33, v17, v208
    v_and_b32 v34, v16, v209
    v_and_b32 v35, v17, v209
    v_and_b32 v36, v16, v210
    v_and_b32 v37, v17, v210
    v_and_b32 v38, v16, v211
    v_and_b32 v39, v17, v211
    v_and_b32 v40, v16, v212
    v_and_b32 v41, v17, v212
    v_and_b32 v42, v16, v213
    v_and_b32 v43, v17, v213
    v_and_b32 v44, v16, v214
    v_and_b32 v45, v17, v214
    v_and_b32 v46, v16, v215
    v_and_b32 v47, v17, v215
    v_mfma_f32_16x16x16_bf16 v[20:23], v[192:193], v[32:33], 0
    v_mfma_f32_16x16x16_bf16 v[20:23], v[194:195], v[34:35], v[20:23]
    v_mfma_f32_16x16x16_bf16 v[20:23], v[196:197], v[36:37], v[20:23]
    v_mfma_f32_16x16x16_bf16 v[20:23], v[198:199], v[38:39], v[20:23]
    v_mfma_f32_16x16x16_bf16 v[20:23], v[200:201], v[40:41], v[20:23]
    v_mfma_f32_16x16x16_bf16 v[20:23], v[202:203], v[42:43], v[20:23]
    v_mfma_f32_16x16x16_bf16 v[20:23], v[204:205], v[44:45], v[20:23]
    v_mfma_f32_16x16x16_bf16 v[20:23], v[206:207], v[46:47], v[20:23]
    s_nop 7
    v_cvt_pk_bf16_f32 v24, v20, v21
    v_cvt_pk_bf16_f32 v25, v22, v23
    s_mov_b64 exec, s[74:75]
    buffer_store_dwordx4 v[24:27], v31, s[48:51], s66 offen sc1
    s_mov_b64 exec, -1
    s_branch L_fin
L_final:
    s_cmp_lg_u32 s3, 1
    s_cbranch_scc1 L_fin
    s_mov_b32 s101, s53
    s_cmp_ge_u32 s101, 4
    s_cbranch_scc1 L_fin
    s_lshl_b32 s101, s101, 3
    s_add_u32 s101, s101, s52
    v_lshrrev_b32 v16, 2, v1
    v_and_b32 v17, 3, v1
    v_lshlrev_b32 v7, 11, v16
    v_lshl_add_u32 v9, v17, 6, v7
    v_lshl_add_u32 v7, v17, 4, v7
    v_lshlrev_b32 v8, 5, v17
    s_lshl_b32 s64, s101, 6
    s_add_u32 s64, s64, 1310720
    s_lshr_b32 s100, s101, 3
    s_lshl_b32 s100, s100, 8
    s_and_b32 s65, s101, 1
    s_lshl_b32 s65, s65, 7
    s_add_u32 s100, s100, s65
    s_bfe_u32 s65, s101, 0x20001
    s_lshl_b32 s65, s65, 3
    s_add_u32 s100, s100, s65
    s_lshl_b32 s65, s100, 1
    s_add_u32 s65, s65, 1179648
    buffer_load_dwordx2 v[84:85], v8, s[40:43], s100 offen
    buffer_load_dwordx2 v[98:99], v8, s[4:7], s100 offen
    v_add_u32 v91, 32768, v7
    v_add_u32 v92, 65536, v7
    v_add_u32 v93, 98304, v7
    v_add_u32 v94, 131072, v7
    v_add_u32 v95, 163840, v7
    v_add_u32 v96, 196608, v7
    s_mov_b32 s79, 0
    s_mov_b64 exec, -1
    buffer_load_dwordx4 v[60:63], v9, s[48:51], s65 offen sc1
    s_branch Lc_c2_77
Lp_c2_75:
    s_mov_b64 exec, s[80:81]
    s_cbranch_execz Ls_78
    buffer_load_dwordx4 v[60:63], v9, s[48:51], s65 offen sc1
Ls_78:
    s_mov_b64 exec, -1
Lc_c2_77:
    s_waitcnt vmcnt(0)
    v_cmp_ne_u64 s[80:81], v[62:63], s[60:61]
    s_mov_b64 s[76:77], s[80:81]
    s_add_u32 s79, s79, 1
    s_cmp_gt_u32 s79, 100000
    s_cbranch_scc1 Lq_c2_76
    s_cmp_lg_u64 s[76:77], 0
    s_cbranch_scc1 Lp_c2_75
Lq_c2_76:
    s_mov_b64 exec, -1
    v_mfma_f32_16x16x16_bf16 v[20:23], v[80:81], v[60:61], 0
    v_lshlrev_b32 v86, 16, v84
    v_and_b32 v87, 0xffff0000, v84
    v_lshlrev_b32 v88, 16, v85
    v_and_b32 v89, 0xffff0000, v85
    v_lshlrev_b32 v100, 16, v98
    v_and_b32 v101, 0xffff0000, v98
    v_lshlrev_b32 v102, 16, v99
    v_and_b32 v103, 0xffff0000, v99
    v_add_f32 v86, v86, v100
    v_add_f32 v87, v87, v101
    v_add_f32 v88, v88, v102
    v_add_f32 v89, v89, v103
    s_mov_b32 s79, 0
    s_mov_b64 exec, -1
    buffer_load_dwordx4 v[32:35], v7, s[48:51], s64 offen sc1
    buffer_load_dwordx4 v[36:39], v91, s[48:51], s64 offen sc1
    buffer_load_dwordx4 v[40:43], v92, s[48:51], s64 offen sc1
    buffer_load_dwordx4 v[44:47], v93, s[48:51], s64 offen sc1
    buffer_load_dwordx4 v[48:51], v94, s[48:51], s64 offen sc1
    buffer_load_dwordx4 v[52:55], v95, s[48:51], s64 offen sc1
    buffer_load_dwordx4 v[56:59], v96, s[48:51], s64 offen sc1
    s_branch Lc_e_81
Lp_e_79:
    s_mov_b64 exec, s[80:81]
    s_cbranch_execz Ls_82
    buffer_load_dwordx4 v[32:35], v7, s[48:51], s64 offen sc1
Ls_82:
    s_mov_b64 exec, s[82:83]
    s_cbranch_execz Ls_83
    buffer_load_dwordx4 v[36:39], v91, s[48:51], s64 offen sc1
Ls_83:
    s_mov_b64 exec, s[84:85]
    s_cbranch_execz Ls_84
    buffer_load_dwordx4 v[40:43], v92, s[48:51], s64 offen sc1
Ls_84:
    s_mov_b64 exec, s[86:87]
    s_cbranch_execz Ls_85
    buffer_load_dwordx4 v[44:47], v93, s[48:51], s64 offen sc1
Ls_85:
    s_mov_b64 exec, s[88:89]
    s_cbranch_execz Ls_86
    buffer_load_dwordx4 v[48:51], v94, s[48:51], s64 offen sc1
Ls_86:
    s_mov_b64 exec, s[68:69]
    s_cbranch_execz Ls_87
    buffer_load_dwordx4 v[52:55], v95, s[48:51], s64 offen sc1
Ls_87:
    s_mov_b64 exec, s[70:71]
    s_cbranch_execz Ls_88
    buffer_load_dwordx4 v[56:59], v96, s[48:51], s64 offen sc1
Ls_88:
    s_mov_b64 exec, -1
Lc_e_81:
    s_waitcnt vmcnt(0)
    v_cmp_ne_u64 s[80:81], v[34:35], s[60:61]
    v_cmp_ne_u64 s[82:83], v[38:39], s[60:61]
    v_cmp_ne_u64 s[84:85], v[42:43], s[60:61]
    v_cmp_ne_u64 s[86:87], v[46:47], s[60:61]
    v_cmp_ne_u64 s[88:89], v[50:51], s[60:61]
    v_cmp_ne_u64 s[68:69], v[54:55], s[60:61]
    v_cmp_ne_u64 s[70:71], v[58:59], s[60:61]
    s_mov_b64 s[76:77], s[80:81]
    s_or_b64 s[76:77], s[76:77], s[82:83]
    s_or_b64 s[76:77], s[76:77], s[84:85]
    s_or_b64 s[76:77], s[76:77], s[86:87]
    s_or_b64 s[76:77], s[76:77], s[88:89]
    s_or_b64 s[76:77], s[76:77], s[68:69]
    s_or_b64 s[76:77], s[76:77], s[70:71]
    s_add_u32 s79, s79, 1
    s_cmp_gt_u32 s79, 100000
    s_cbranch_scc1 Lq_e_80
    s_cmp_lg_u64 s[76:77], 0
    s_cbranch_scc1 Lp_e_79
Lq_e_80:
    s_mov_b64 exec, -1
    v_mfma_f32_16x16x16_bf16 v[20:23], v[80:81], v[32:33], v[20:23]
    v_mfma_f32_16x16x16_bf16 v[20:23], v[80:81], v[36:37], v[20:23]
    v_mfma_f32_16x16x16_bf16 v[20:23], v[80:81], v[40:41], v[20:23]
    v_mfma_f32_16x16x16_bf16 v[20:23], v[80:81], v[44:45], v[20:23]
    v_mfma_f32_16x16x16_bf16 v[20:23], v[80:81], v[48:49], v[20:23]
    v_mfma_f32_16x16x16_bf16 v[20:23], v[80:81], v[52:53], v[20:23]
    v_mfma_f32_16x16x16_bf16 v[20:23], v[80:81], v[56:57], v[20:23]
    s_nop 7
    v_add_f32_dpp v20, v20, v20 row_ror:4 row_mask:0xf bank_mask:0xf
    v_add_f32_dpp v21, v21, v21 row_ror:4 row_mask:0xf bank_mask:0xf
    v_add_f32_dpp v22, v22, v22 row_ror:4 row_mask:0xf bank_mask:0xf
    v_add_f32_dpp v23, v23, v23 row_ror:4 row_mask:0xf bank_mask:0xf
    v_add_f32_dpp v20, v20, v20 row_ror:8 row_mask:0xf bank_mask:0xf
    v_add_f32_dpp v21, v21, v21 row_ror:8 row_mask:0xf bank_mask:0xf
    v_add_f32_dpp v22, v22, v22 row_ror:8 row_mask:0xf bank_mask:0xf
    v_add_f32_dpp v23, v23, v23 row_ror:8 row_mask:0xf bank_mask:0xf
    v_add_f32 v20, v20, v86
    v_add_f32 v21, v21, v87
    v_add_f32 v22, v22, v88
    v_add_f32 v23, v23, v89
    v_cvt_pk_bf16_f32 v24, v20, v21
    v_cvt_pk_bf16_f32 v25, v22, v23
    s_mov_b64 exec, 15
    buffer_store_dwordx2 v[24:25], v8, s[44:47], s100 offen
    s_cmp_lg_u32 s101, 0
    s_cbranch_scc1 L_fin
    s_mov_b64 exec, 1
    v_mov_b32 v26, s60
    v_mov_b32 v27, 0
    buffer_store_dword v26, v27, s[48:51], 0 offen sc1
L_fin:
L_exit:
    s_endpgm

.section .rodata,"a"
.p2align 6
.amdhsa_kernel sequential_preLN__compressed_kv_cla__dense_activation_gelu__decode_kernel
  .amdhsa_next_free_vgpr 256
  .amdhsa_next_free_sgpr 102
  .amdhsa_accum_offset 256
  .amdhsa_group_segment_fixed_size 0
  .amdhsa_kernarg_size 112
  .amdhsa_user_sgpr_count 2
  .amdhsa_user_sgpr_kernarg_segment_ptr 1
  .amdhsa_system_sgpr_workgroup_id_x 1
  .amdhsa_float_denorm_mode_32 3
  .amdhsa_float_denorm_mode_16_64 3
.end_amdhsa_kernel
```
